```python
import torch

def _softmax(x, axis=-1):
    return torch.softmax(x, dim=axis)

def _gelu(x):
    return torch.nn.functional.gelu(x, approximate='tanh')

def _silu(x):
    return torch.nn.functional.silu(x)

def _sigmoid(x):
    return torch.sigmoid(x)

def _layernorm(x, axis=-1, eps=1e-05):
    m = x.mean(dim=axis, keepdim=True)
    v = x.var(dim=axis, keepdim=True, unbiased=False)
    return (x - m) / torch.sqrt(v + eps)

def _scatter_add(tgt, idx, src, axis=0):
    return tgt.clone().index_add_(axis, idx, src)

def _segment_sum(src, seg, n):
    out = torch.zeros((n,) + src.shape[1:], dtype=src.dtype)
    return out.index_add_(0, seg, src)

def _pad(x, pw):
    flat = tuple((v for pair in reversed(pw) for v in pair))
    return torch.nn.functional.pad(x, flat)
kernel_name = 'parallel_sum__softmax_full_mha__mixer_gmlp__prompt'

def setup_inputs():

    _w = lambda a: (lambda t: t.to(torch.bfloat16) if t.is_floating_point() else t)(torch.as_tensor(a))

    def _A_setup():
        B, S, D = (1, 2048, 640)
        return {'x': _w((lambda *s: torch.randn(*s, dtype=torch.bfloat16) * 0.05)(B, S, D)), 'wqkv': _w((lambda *s: torch.randn(*s, dtype=torch.bfloat16) * 0.2)(D, 3 * D)), 'wo': _w((lambda *s: torch.randn(*s, dtype=torch.bfloat16) * 0.1)(D, D))}
    _A_in = _A_setup()

    def _B_setup():
        B, S, D, F = (1, 2048, 640, 1536)
        Fh = F // 2
        return {'x': _w((lambda *s: torch.randn(*s, dtype=torch.bfloat16) * 0.05)(B, S, D)), 'w_in': _w((lambda *s: torch.randn(*s, dtype=torch.bfloat16) * 0.8)(D, 2 * Fh)), 'w_sp': _w(0.01 * (lambda *s: torch.randn(*s, dtype=torch.bfloat16) * 0.8)(S, S)), 'b_sp': _w(1.0 + 0.01 * (lambda *s: torch.randn(*s, dtype=torch.bfloat16) * 0.2)(S)), 'w_out': _w((lambda *s: torch.randn(*s, dtype=torch.bfloat16) * 0.2)(Fh, D))}
    _B_in = _B_setup()
    return {'A_x': _A_in['x'], 'A_wqkv': _A_in['wqkv'], 'A_wo': _A_in['wo'], 'B_x': _B_in['x'], 'B_w_in': _B_in['w_in'], 'B_w_sp': _B_in['w_sp'], 'B_b_sp': _B_in['b_sp'], 'B_w_out': _B_in['w_out']}

def reference(A_x, A_wqkv, A_wo, B_x, B_w_in, B_w_sp, B_b_sp, B_w_out):

    def _A_ref(x, wqkv, wo):
        B, S, D = x.shape
        H = 32
        Dh = D // H
        qkv = (lambda x, *d: x.permute(*d))((x @ wqkv).reshape(B, S, 3, H, Dh), 2, 0, 3, 1, 4)
        q, k, v = (qkv[0], qkv[1], qkv[2])
        scale = Dh ** (-0.5)
        scores = torch.einsum('bhqd,bhkd->bhqk', q, k) * scale
        p = _softmax(scores, axis=-1)
        o = torch.einsum('bhqk,bhkd->bhqd', p, v)
        return (lambda x, *d: x.permute(*d))(o, 0, 2, 1, 3).reshape(B, S, D) @ wo

    def _B_ref(x, w_in, w_sp, b_sp, w_out):
        B, S, D = x.shape
        F = w_in.shape[-1]
        Fh = F // 2
        z = _gelu(torch.einsum('bsd,df->bsf', x, w_in))
        z1 = z[..., :Fh].clone()
        z2 = _layernorm(z[..., Fh:], axis=-1)
        g = torch.einsum('ts,bsf->btf', w_sp, z2) + b_sp[None, :, None]
        return torch.einsum('bsf,fd->bsd', z1 * g, w_out)
    x = A_x
    xn = _layernorm(x, axis=-1)
    return x + _A_ref(xn, A_wqkv, A_wo) + _B_ref(xn, B_w_in, B_w_sp, B_b_sp, B_w_out)
```

```asm
; @launch grid=(256,1,1) block=(768,1,1) lds=163328
.amdgcn_target "amdgcn-amd-amdhsa--gfx950"
.text
.globl parallel_sum__softmax_full_mha__mixer_gmlp__prompt_kernel
.p2align 8
.type parallel_sum__softmax_full_mha__mixer_gmlp__prompt_kernel,@function
parallel_sum__softmax_full_mha__mixer_gmlp__prompt_kernel:
    s_getpc_b64 s[94:95]
    s_cmp_ge_u32 s2, 256
    s_cbranch_scc1 MK_END
    s_load_dwordx16 s[64:79], s[0:1], 0
    s_load_dwordx4 s[80:83], s[0:1], 64
    s_load_dwordx2 s[84:85], s[0:1], 80
    s_lshr_b32 s3, s2, 3
    s_and_b32 s3, s3, 7
    v_lshlrev_b32 v166, 3, v0
    v_add_lshl_u32 v166, v166, s3, 7
    v_cmp_gt_u32 vcc, CODE_END-parallel_sum__softmax_full_mha__mixer_gmlp__prompt_kernel-64, v166
    s_nop 0
    s_and_saveexec_b64 s[96:97], vcc
    s_cbranch_execz MK_NOPF
    global_load_dword v167, v166, s[94:95]
MK_NOPF:
    s_mov_b64 exec, s[96:97]
    v_lshrrev_b32 v1, 6, v0
    v_and_b32 v2, 63, v0
    v_readfirstlane_b32 s33, v1
    s_and_b32 s34, s2, 7
    s_lshr_b32 s35, s2, 3
    s_and_b32 s40, s34, 1
    s_lshl_b32 s40, s40, 3
    s_and_b32 s41, s35, 7
    s_add_u32 s36, s40, s41
    s_lshr_b32 s40, s34, 1
    s_lshl_b32 s40, s40, 2
    s_lshr_b32 s41, s35, 3
    s_add_u32 s37, s40, s41
    s_xor_b32 s32, s37, 8
    s_lshl_b32 s40, s34, 2
    s_and_b32 s41, s35, 3
    s_add_u32 s38, s40, s41
    s_lshr_b32 s39, s35, 2
    s_mov_b32 s87, 0
    s_waitcnt lgkmcnt(0)
    s_mov_b32 s8, s64
    s_mov_b32 s9, s65
    s_mov_b32 s10, 0x280000
    s_mov_b32 s11, 0x00020000
    s_mov_b32 s12, s66
    s_mov_b32 s13, s67
    s_mov_b32 s14, 0x258000
    s_mov_b32 s15, 0x00020000
    s_mov_b32 s16, s84
    s_mov_b32 s17, s85
    s_mov_b32 s18, 0x1a4c000
    s_mov_b32 s19, 0x00020000
    s_mov_b32 s20, s72
    s_mov_b32 s21, s73
    s_mov_b32 s22, 0x1e0000
    s_mov_b32 s23, 0x00020000
    s_cmp_ge_u32 s33, 8
    s_cbranch_scc1 MK_P

    s_setprio 0
    s_cmp_ge_u32 s33, 4
    s_cbranch_scc1 MK_B0
    s_cmp_lt_u32 s33, 2
    s_cselect_b32 s24, s66, s72
    s_cselect_b32 s25, s67, s73
    s_mov_b32 s26, 0x1e0000
    s_cselect_b32 s26, 0x258000, s26
    s_mov_b32 s27, 0x00020000
    s_mov_b32 s46, 3072
    s_cselect_b32 s46, 3840, s46
    s_mov_b32 s47, 192
    s_cselect_b32 s47, 256, s47
    s_cselect_b32 s48, s37, s32
    s_mul_i32 s47, s47, s48
    s_and_b32 s48, s33, 1
    s_lshl_b32 s48, s48, 7
    s_add_u32 s47, s47, s48
    s_mul_i32 s48, s36, 40
    s_mul_i32 s48, s48, s46
    s_add_u32 s47, s47, s48
    s_lshl_b32 s48, s46, 3
    v_lshrrev_b32 v18, 3, v2
    v_mul_lo_u32 v18, v18, s46
    v_and_b32 v19, 7, v2
    v_lshl_add_u32 v18, v19, 4, v18
    buffer_load_dwordx4 v[60:63], v18, s[24:27], s47 offen
    s_add_u32 s47, s47, s48
    buffer_load_dwordx4 v[64:67], v18, s[24:27], s47 offen
    s_add_u32 s47, s47, s48
    buffer_load_dwordx4 v[68:71], v18, s[24:27], s47 offen
    s_add_u32 s47, s47, s48
    buffer_load_dwordx4 v[72:75], v18, s[24:27], s47 offen
    s_add_u32 s47, s47, s48
    buffer_load_dwordx4 v[76:79], v18, s[24:27], s47 offen
    s_or_b32 s40, s33, s2
    s_cmp_lg_u32 s40, 0
    s_cbranch_scc1 MK_A
    s_mov_b32 s28, s82
    s_mov_b32 s29, s83
    s_mov_b32 s30, 0x100
    s_mov_b32 s31, 0x00020000
    v_lshlrev_b32 v8, 6, v2
    s_memrealtime s[40:41]
    s_waitcnt lgkmcnt(0)
    s_or_b32 s40, s40, 1
    v_mov_b32 v9, s40
    buffer_store_dword v9, v8, s[28:31], 0 offen sc1
    s_branch MK_A
MK_B0:
    v_and_b32 v3, 31, v2
    v_lshrrev_b32 v4, 5, v2
    s_sub_u32 s40, s33, 4
    s_lshl_b32 s44, s36, 7
    s_lshl_b32 s45, s37, 3
    s_add_u32 s44, s44, s45
    s_lshl_b32 s45, s40, 1
    s_add_u32 s44, s44, s45
    s_mul_i32 s45, s44, 1280
    v_mul_u32_u24 v58, 1280, v4
    v_lshl_add_u32 v16, v3, 4, v58
    v_lshl_add_u32 v17, v3, 3, v58
    buffer_load_dwordx4 v[48:51], v16, s[8:11], s45 offen
    buffer_load_dwordx4 v[52:55], v16, s[8:11], s45 offen offset:512
    buffer_load_dwordx2 v[56:57], v17, s[8:11], s45 offen offset:1024
    s_branch MK_B
MK_P:
    s_setprio 0
    s_sub_u32 s40, s33, 8
    s_cmp_eq_u32 s37, 15
    s_cselect_b32 s14, 0, s14
    v_lshrrev_b32 v4, 3, v2
    v_mul_u32_u24 v3, 1280, v4
    v_lshrrev_b32 v5, 4, v2
    s_and_b32 s41, s40, 1
    s_lshl_b32 s41, s41, 2
    v_add_u32 v6, s41, v5
    v_and_b32 v7, 7, v2
    v_xor_b32 v6, v6, v7
    v_lshl_add_u32 v3, v6, 4, v3
    s_lshl_b32 s42, s36, 7
    s_lshl_b32 s43, s40, 3
    s_add_u32 s42, s42, s43
    s_mul_i32 s42, s42, 1280
    s_lshl_b32 s44, s40, 10
    v_mul_u32_u24 v8, 3840, v5
    v_and_b32 v9, 15, v2
    v_lshlrev_b32 v10, 2, v5
    v_xor_b32 v9, v9, v10
    v_lshl_add_u32 v8, v9, 4, v8
    s_mul_i32 s45, s40, 15360
    s_lshl_b32 s46, s37, 8
    s_add_u32 s45, s45, s46
    s_add_u32 m0, s44, 0
    s_add_u32 s50, s42, 0
    buffer_load_dwordx4 v3, s[8:11], s50 offen lds
    s_add_u32 m0, s44, 16384
    s_add_u32 s50, s45, 0
    buffer_load_dwordx4 v8, s[12:15], s50 offen lds
    s_add_u32 m0, s44, 4096
    s_add_u32 s50, s42, 40960
    buffer_load_dwordx4 v3, s[8:11], s50 offen lds
    s_add_u32 m0, s44, 20480
    s_add_u32 s50, s45, 61440
    buffer_load_dwordx4 v8, s[12:15], s50 offen lds
    s_add_u32 m0, s44, 8192
    s_add_u32 s50, s42, 81920
    buffer_load_dwordx4 v3, s[8:11], s50 offen lds
    s_add_u32 m0, s44, 24576
    s_add_u32 s50, s45, 122880
    buffer_load_dwordx4 v8, s[12:15], s50 offen lds
    s_add_u32 m0, s44, 12288
    s_add_u32 s50, s42, 122880
    buffer_load_dwordx4 v3, s[8:11], s50 offen lds
    s_add_u32 m0, s44, 28672
    s_add_u32 s50, s45, 184320
    buffer_load_dwordx4 v8, s[12:15], s50 offen lds
    v_add_u32 v12, 0, v2
    v_mul_u32_u24 v13, 5462, v12
    v_lshrrev_b32 v13, 16, v13
    v_mul_u32_u24 v14, 12, v13
    v_sub_u32 v14, v12, v14
    v_mul_u32_u24 v9, 3072, v13
    v_lshl_add_u32 v9, v14, 4, v9
    v_add_u32 v12, 64, v2
    v_mul_u32_u24 v13, 5462, v12
    v_lshrrev_b32 v13, 16, v13
    v_mul_u32_u24 v14, 12, v13
    v_sub_u32 v14, v12, v14
    v_mul_u32_u24 v10, 3072, v13
    v_lshl_add_u32 v10, v14, 4, v10
    v_add_u32 v12, 128, v2
    v_mul_u32_u24 v13, 5462, v12
    v_lshrrev_b32 v13, 16, v13
    v_mul_u32_u24 v14, 12, v13
    v_sub_u32 v14, v12, v14
    v_mul_u32_u24 v11, 3072, v13
    v_lshl_add_u32 v11, v14, 4, v11
    s_mul_i32 s47, s40, 49152
    s_mul_i32 s46, s32, 192
    s_add_u32 s47, s47, s46
    s_mul_i32 s48, s40, 3072
    s_add_u32 m0, s48, 32768
    s_add_u32 s50, s47, 0
    buffer_load_dwordx4 v9, s[20:23], s50 offen lds
    s_add_u32 m0, s48, 33792
    s_add_u32 s50, s47, 0
    buffer_load_dwordx4 v10, s[20:23], s50 offen lds
    s_add_u32 m0, s48, 34816
    s_add_u32 s50, s47, 0
    buffer_load_dwordx4 v11, s[20:23], s50 offen lds
    s_setprio 0
    s_add_u32 m0, s44, 45056
    s_add_u32 s50, s42, 128
    buffer_load_dwordx4 v3, s[8:11], s50 offen lds
    s_add_u32 m0, s44, 61440
    s_add_u32 s50, s45, 245760
    buffer_load_dwordx4 v8, s[12:15], s50 offen lds
    s_add_u32 m0, s48, 77824
    s_add_u32 s50, s47, 196608
    buffer_load_dwordx4 v9, s[20:23], s50 offen lds
    s_add_u32 m0, s44, 49152
    s_add_u32 s50, s42, 41088
    buffer_load_dwordx4 v3, s[8:11], s50 offen lds
    s_add_u32 m0, s44, 65536
    s_add_u32 s50, s45, 307200
    buffer_load_dwordx4 v8, s[12:15], s50 offen lds
    s_add_u32 m0, s48, 78848
    s_add_u32 s50, s47, 196608
    buffer_load_dwordx4 v10, s[20:23], s50 offen lds
    s_add_u32 m0, s44, 53248
    s_add_u32 s50, s42, 82048
    buffer_load_dwordx4 v3, s[8:11], s50 offen lds
    s_add_u32 m0, s44, 69632
    s_add_u32 s50, s45, 368640
    buffer_load_dwordx4 v8, s[12:15], s50 offen lds
    s_add_u32 m0, s48, 79872
    s_add_u32 s50, s47, 196608
    buffer_load_dwordx4 v11, s[20:23], s50 offen lds
    s_add_u32 m0, s44, 57344
    s_add_u32 s50, s42, 123008
    buffer_load_dwordx4 v3, s[8:11], s50 offen lds
    s_add_u32 m0, s44, 73728
    s_add_u32 s50, s45, 430080
    buffer_load_dwordx4 v8, s[12:15], s50 offen lds
    s_add_u32 m0, s44, 90112
    s_add_u32 s50, s42, 256
    buffer_load_dwordx4 v3, s[8:11], s50 offen lds
    s_add_u32 m0, s44, 106496
    s_add_u32 s50, s45, 491520
    buffer_load_dwordx4 v8, s[12:15], s50 offen lds
    s_add_u32 m0, s48, 122880
    s_add_u32 s50, s47, 393216
    buffer_load_dwordx4 v9, s[20:23], s50 offen lds
    s_add_u32 m0, s44, 94208
    s_add_u32 s50, s42, 41216
    buffer_load_dwordx4 v3, s[8:11], s50 offen lds
    s_add_u32 m0, s44, 110592
    s_add_u32 s50, s45, 552960
    buffer_load_dwordx4 v8, s[12:15], s50 offen lds
    s_add_u32 m0, s48, 123904
    s_add_u32 s50, s47, 393216
    buffer_load_dwordx4 v10, s[20:23], s50 offen lds
    s_add_u32 m0, s44, 98304
    s_add_u32 s50, s42, 82176
    buffer_load_dwordx4 v3, s[8:11], s50 offen lds
    s_add_u32 m0, s44, 114688
    s_add_u32 s50, s45, 614400
    buffer_load_dwordx4 v8, s[12:15], s50 offen lds
    s_add_u32 m0, s48, 124928
    s_add_u32 s50, s47, 393216
    buffer_load_dwordx4 v11, s[20:23], s50 offen lds
    s_add_u32 m0, s44, 102400
    s_add_u32 s50, s42, 123136
    buffer_load_dwordx4 v3, s[8:11], s50 offen lds
    s_add_u32 m0, s44, 118784
    s_add_u32 s50, s45, 675840
    buffer_load_dwordx4 v8, s[12:15], s50 offen lds

    v_and_b32 v6, 31, v2
    v_lshrrev_b32 v7, 5, v2
    s_lshl_b32 s53, s36, 2
    s_add_u32 s53, s53, s40
    s_lshl_b32 s53, s53, 8
    s_add_u32 s53, s53, 0x17b8000
    v_lshlrev_b32 v42, 3, v6
    s_lshl_b32 s54, s37, 13
    s_lshl_b32 s51, s40, 7
    s_add_u32 s54, s54, s51
    s_add_u32 s54, s54, 0x17bc000
    v_and_b32 v14, 7, v2
    v_lshlrev_b32 v14, 4, v14
    v_lshrrev_b32 v43, 3, v2
    v_lshl_add_u32 v43, v43, 9, v14
    s_add_u32 s50, s51, 136192
    v_lshl_add_u32 v40, v6, 2, s50
    v_add_u32 v41, s50, v14
    v_lshl_add_u32 v41, v7, 9, v41
    v_bfe_u32 v22, v2, 4, 1
    v_lshl_add_u32 v41, v22, 3, v41
    s_mov_b32 s28, s82
    s_mov_b32 s29, s83
    s_mov_b32 s30, 0x100
    s_mov_b32 s31, 0x00020000
    s_lshl_b32 s55, s40, 6
    v_mov_b32 v44, s55
    s_lshl_b32 s55, s40, 2
    s_add_u32 s55, s55, 162848
    v_mov_b32 v46, s55
    v_and_b32 v49, 7, v2
    v_lshlrev_b32 v49, 2, v49
    v_add_u32 v49, 162992, v49
    s_waitcnt vmcnt(22)

    s_barrier

    buffer_load_dword v45, v44, s[28:31], 0 offen sc1
    s_waitcnt vmcnt(12)
    s_barrier

    s_add_u32 m0, s44, 0
    s_add_u32 s50, s42, 384
    buffer_load_dwordx4 v3, s[8:11], s50 offen lds
    s_add_u32 m0, s44, 16384
    s_add_u32 s50, s45, 737280
    buffer_load_dwordx4 v8, s[12:15], s50 offen lds
    s_add_u32 m0, s48, 32768
    s_add_u32 s50, s47, 589824
    buffer_load_dwordx4 v9, s[20:23], s50 offen lds
    s_add_u32 m0, s44, 4096
    s_add_u32 s50, s42, 41344
    buffer_load_dwordx4 v3, s[8:11], s50 offen lds
    s_add_u32 m0, s44, 20480
    s_add_u32 s50, s45, 798720
    buffer_load_dwordx4 v8, s[12:15], s50 offen lds
    s_add_u32 m0, s48, 33792
    s_add_u32 s50, s47, 589824
    buffer_load_dwordx4 v10, s[20:23], s50 offen lds
    s_add_u32 m0, s44, 8192
    s_add_u32 s50, s42, 82304
    buffer_load_dwordx4 v3, s[8:11], s50 offen lds
    s_add_u32 m0, s44, 24576
    s_add_u32 s50, s45, 860160
    buffer_load_dwordx4 v8, s[12:15], s50 offen lds
    s_add_u32 m0, s48, 34816
    s_add_u32 s50, s47, 589824
    buffer_load_dwordx4 v11, s[20:23], s50 offen lds
    s_add_u32 m0, s44, 12288
    s_add_u32 s50, s42, 123264
    buffer_load_dwordx4 v3, s[8:11], s50 offen lds
    s_add_u32 m0, s44, 28672
    s_add_u32 s50, s45, 921600
    buffer_load_dwordx4 v8, s[12:15], s50 offen lds
    s_waitcnt vmcnt(12)
    s_barrier

    s_waitcnt vmcnt(11)
    s_mov_b32 s52, 0
MK_TOKL:
    v_readfirstlane_b32 s86, v45
    s_nop 0
    s_cmp_lg_u32 s86, 0
    s_cbranch_scc1 MK_TOKD
    s_add_u32 s52, s52, 1
    s_cmp_gt_u32 s52, 200000
    s_cbranch_scc1 MK_TOKD
    s_sleep 4
    buffer_load_dword v45, v44, s[28:31], 0 offen sc1
    s_waitcnt vmcnt(0)
    s_branch MK_TOKL
MK_TOKD:
    s_cmp_lg_u32 s40, 0
    s_cbranch_scc1 MK_NOS1
    v_mov_b32 v16, 162836
    ds_write_b32 v16, v45
    s_lshl_b32 s51, s2, 2
    s_add_u32 s51, s51, 0x183e000
    s_mov_b64 exec, 0xff
    v_mov_b32 v16, s86
    v_lshlrev_b32 v17, 10, v2
    buffer_store_dword v16, v17, s[16:19], s51 offen sc1
    s_mov_b64 exec, -1
MK_NOS1:

    s_add_u32 m0, s44, 45056
    s_add_u32 s50, s42, 512
    buffer_load_dwordx4 v3, s[8:11], s50 offen lds
    s_add_u32 m0, s44, 61440
    s_add_u32 s50, s45, 983040
    buffer_load_dwordx4 v8, s[12:15], s50 offen lds
    s_add_u32 m0, s48, 77824
    s_add_u32 s50, s47, 786432
    buffer_load_dwordx4 v9, s[20:23], s50 offen lds
    s_add_u32 m0, s44, 49152
    s_add_u32 s50, s42, 41472
    buffer_load_dwordx4 v3, s[8:11], s50 offen lds
    s_add_u32 m0, s44, 65536
    s_add_u32 s50, s45, 1044480
    buffer_load_dwordx4 v8, s[12:15], s50 offen lds
    s_add_u32 m0, s48, 78848
    s_add_u32 s50, s47, 786432
    buffer_load_dwordx4 v10, s[20:23], s50 offen lds
    s_add_u32 m0, s44, 53248
    s_add_u32 s50, s42, 82432
    buffer_load_dwordx4 v3, s[8:11], s50 offen lds
    s_add_u32 m0, s44, 69632
    s_add_u32 s50, s45, 1105920
    buffer_load_dwordx4 v8, s[12:15], s50 offen lds
    s_add_u32 m0, s48, 79872
    s_add_u32 s50, s47, 786432
    buffer_load_dwordx4 v11, s[20:23], s50 offen lds
    s_add_u32 m0, s44, 57344
    s_add_u32 s50, s42, 123392
    buffer_load_dwordx4 v3, s[8:11], s50 offen lds
    s_add_u32 m0, s44, 73728
    s_add_u32 s50, s45, 1167360
    buffer_load_dwordx4 v8, s[12:15], s50 offen lds
    s_waitcnt vmcnt(11)
    s_barrier

    s_add_u32 m0, s44, 90112
    s_add_u32 s50, s42, 640
    buffer_load_dwordx4 v3, s[8:11], s50 offen lds
    s_add_u32 m0, s44, 106496
    s_add_u32 s50, s45, 1228800
    buffer_load_dwordx4 v8, s[12:15], s50 offen lds
    s_add_u32 m0, s48, 122880
    s_add_u32 s50, s47, 983040
    buffer_load_dwordx4 v9, s[20:23], s50 offen lds
    s_add_u32 m0, s44, 94208
    s_add_u32 s50, s42, 41600
    buffer_load_dwordx4 v3, s[8:11], s50 offen lds
    s_add_u32 m0, s44, 110592
    s_add_u32 s50, s45, 1290240
    buffer_load_dwordx4 v8, s[12:15], s50 offen lds
    s_add_u32 m0, s48, 123904
    s_add_u32 s50, s47, 983040
    buffer_load_dwordx4 v10, s[20:23], s50 offen lds
    s_add_u32 m0, s44, 98304
    s_add_u32 s50, s42, 82560
    buffer_load_dwordx4 v3, s[8:11], s50 offen lds
    s_add_u32 m0, s44, 114688
    s_add_u32 s50, s45, 1351680
    buffer_load_dwordx4 v8, s[12:15], s50 offen lds
    s_add_u32 m0, s48, 124928
    s_add_u32 s50, s47, 983040
    buffer_load_dwordx4 v11, s[20:23], s50 offen lds
    s_add_u32 m0, s44, 102400
    s_add_u32 s50, s42, 123520
    buffer_load_dwordx4 v3, s[8:11], s50 offen lds
    s_add_u32 m0, s44, 118784
    s_add_u32 s50, s45, 1413120
    buffer_load_dwordx4 v8, s[12:15], s50 offen lds
    s_waitcnt vmcnt(11)
    s_barrier

    s_add_u32 m0, s44, 0
    s_add_u32 s50, s42, 768
    buffer_load_dwordx4 v3, s[8:11], s50 offen lds
    s_add_u32 m0, s44, 16384
    s_add_u32 s50, s45, 1474560
    buffer_load_dwordx4 v8, s[12:15], s50 offen lds
    s_add_u32 m0, s48, 32768
    s_add_u32 s50, s47, 1179648
    buffer_load_dwordx4 v9, s[20:23], s50 offen lds
    s_add_u32 m0, s44, 4096
    s_add_u32 s50, s42, 41728
    buffer_load_dwordx4 v3, s[8:11], s50 offen lds
    s_add_u32 m0, s44, 20480
    s_add_u32 s50, s45, 1536000
    buffer_load_dwordx4 v8, s[12:15], s50 offen lds
    s_add_u32 m0, s48, 33792
    s_add_u32 s50, s47, 1179648
    buffer_load_dwordx4 v10, s[20:23], s50 offen lds
    s_add_u32 m0, s44, 8192
    s_add_u32 s50, s42, 82688
    buffer_load_dwordx4 v3, s[8:11], s50 offen lds
    s_add_u32 m0, s44, 24576
    s_add_u32 s50, s45, 1597440
    buffer_load_dwordx4 v8, s[12:15], s50 offen lds
    s_add_u32 m0, s48, 34816
    s_add_u32 s50, s47, 1179648
    buffer_load_dwordx4 v11, s[20:23], s50 offen lds
    s_add_u32 m0, s44, 12288
    s_add_u32 s50, s42, 123648
    buffer_load_dwordx4 v3, s[8:11], s50 offen lds
    s_add_u32 m0, s44, 28672
    s_add_u32 s50, s45, 1658880
    buffer_load_dwordx4 v8, s[12:15], s50 offen lds
    s_waitcnt vmcnt(11)
    s_barrier

    v_lshlrev_b32 v15, 4, v2
    s_lshl_b32 s51, s34, 10
    s_add_u32 s51, s51, 0x183e000
    buffer_load_dwordx4 v[16:19], v15, s[16:19], s51 offen sc1
    s_add_u32 m0, s44, 45056
    s_add_u32 s50, s42, 896
    buffer_load_dwordx4 v3, s[8:11], s50 offen lds
    s_add_u32 m0, s44, 61440
    s_add_u32 s50, s45, 1720320
    buffer_load_dwordx4 v8, s[12:15], s50 offen lds
    s_add_u32 m0, s48, 77824
    s_add_u32 s50, s47, 1376256
    buffer_load_dwordx4 v9, s[20:23], s50 offen lds
    s_add_u32 m0, s44, 49152
    s_add_u32 s50, s42, 41856
    buffer_load_dwordx4 v3, s[8:11], s50 offen lds
    s_add_u32 m0, s44, 65536
    s_add_u32 s50, s45, 1781760
    buffer_load_dwordx4 v8, s[12:15], s50 offen lds
    s_add_u32 m0, s48, 78848
    s_add_u32 s50, s47, 1376256
    buffer_load_dwordx4 v10, s[20:23], s50 offen lds
    s_add_u32 m0, s44, 53248
    s_add_u32 s50, s42, 82816
    buffer_load_dwordx4 v3, s[8:11], s50 offen lds
    s_add_u32 m0, s44, 69632
    s_add_u32 s50, s45, 1843200
    buffer_load_dwordx4 v8, s[12:15], s50 offen lds
    s_add_u32 m0, s48, 79872
    s_add_u32 s50, s47, 1376256
    buffer_load_dwordx4 v11, s[20:23], s50 offen lds
    s_add_u32 m0, s44, 57344
    s_add_u32 s50, s42, 123776
    buffer_load_dwordx4 v3, s[8:11], s50 offen lds
    s_add_u32 m0, s44, 73728
    s_add_u32 s50, s45, 1904640
    buffer_load_dwordx4 v8, s[12:15], s50 offen lds
    s_waitcnt vmcnt(12)
    s_barrier

    s_add_u32 m0, s44, 90112
    s_add_u32 s50, s42, 1024
    buffer_load_dwordx4 v3, s[8:11], s50 offen lds
    s_add_u32 m0, s44, 106496
    s_add_u32 s50, s45, 1966080
    buffer_load_dwordx4 v8, s[12:15], s50 offen lds
    s_add_u32 m0, s48, 122880
    s_add_u32 s50, s47, 1572864
    buffer_load_dwordx4 v9, s[20:23], s50 offen lds
    s_add_u32 m0, s44, 94208
    s_add_u32 s50, s42, 41984
    buffer_load_dwordx4 v3, s[8:11], s50 offen lds
    s_add_u32 m0, s44, 110592
    s_add_u32 s50, s45, 2027520
    buffer_load_dwordx4 v8, s[12:15], s50 offen lds
    s_add_u32 m0, s48, 123904
    s_add_u32 s50, s47, 1572864
    buffer_load_dwordx4 v10, s[20:23], s50 offen lds
    s_add_u32 m0, s44, 98304
    s_add_u32 s50, s42, 82944
    buffer_load_dwordx4 v3, s[8:11], s50 offen lds
    s_add_u32 m0, s44, 114688
    s_add_u32 s50, s45, 2088960
    buffer_load_dwordx4 v8, s[12:15], s50 offen lds
    s_add_u32 m0, s48, 124928
    s_add_u32 s50, s47, 1572864
    buffer_load_dwordx4 v11, s[20:23], s50 offen lds
    s_add_u32 m0, s44, 102400
    s_add_u32 s50, s42, 123904
    buffer_load_dwordx4 v3, s[8:11], s50 offen lds
    s_add_u32 m0, s44, 118784
    s_add_u32 s50, s45, 2150400
    buffer_load_dwordx4 v8, s[12:15], s50 offen lds
    s_waitcnt vmcnt(11)
    s_barrier

    s_mov_b32 s52, 0
MK_S1P:
    v_xor_b32 v16, s86, v16
    v_xor_b32 v17, s86, v17
    v_xor_b32 v18, s86, v18
    v_xor_b32 v19, s86, v19
    v_or3_b32 v16, v16, v17, v18
    v_or_b32 v16, v16, v19
    v_cmp_ne_u32 vcc, 0, v16
    s_cbranch_vccz MK_S1P_OK
    s_add_u32 s52, s52, 1
    s_cmp_gt_u32 s52, 200000
    s_cbranch_scc1 MK_S1P_OK
    s_sleep 2
    buffer_load_dwordx4 v[16:19], v15, s[16:19], s51 offen sc1
    s_waitcnt vmcnt(0)
    s_branch MK_S1P
MK_S1P_OK:
    buffer_load_dwordx2 v[20:21], v42, s[16:19], s53 offen sc1
    s_add_u32 s51, s54, 0
    buffer_load_dwordx4 v[24:27], v43, s[16:19], s51 offen sc1
    s_add_u32 s51, s54, 4096
    buffer_load_dwordx4 v[28:31], v43, s[16:19], s51 offen sc1
    s_add_u32 s51, s54, 131072
    buffer_load_dwordx4 v[32:35], v43, s[16:19], s51 offen sc1
    s_add_u32 s51, s54, 135168
    buffer_load_dwordx4 v[36:39], v43, s[16:19], s51 offen sc1
    s_add_u32 m0, s44, 0
    s_add_u32 s50, s42, 1152
    buffer_load_dwordx4 v3, s[8:11], s50 offen lds
    s_add_u32 m0, s44, 16384
    s_add_u32 s50, s45, 2211840
    buffer_load_dwordx4 v8, s[12:15], s50 offen lds
    s_add_u32 m0, s48, 32768
    s_add_u32 s50, s47, 1769472
    buffer_load_dwordx4 v9, s[20:23], s50 offen lds
    s_add_u32 m0, s44, 4096
    s_add_u32 s50, s42, 42112
    buffer_load_dwordx4 v3, s[8:11], s50 offen lds
    s_add_u32 m0, s44, 20480
    s_add_u32 s50, s45, 2273280
    buffer_load_dwordx4 v8, s[12:15], s50 offen lds
    s_add_u32 m0, s48, 33792
    s_add_u32 s50, s47, 1769472
    buffer_load_dwordx4 v10, s[20:23], s50 offen lds
    s_add_u32 m0, s44, 8192
    s_add_u32 s50, s42, 83072
    buffer_load_dwordx4 v3, s[8:11], s50 offen lds
    s_add_u32 m0, s44, 24576
    s_add_u32 s50, s45, 2334720
    buffer_load_dwordx4 v8, s[12:15], s50 offen lds
    s_add_u32 m0, s48, 34816
    s_add_u32 s50, s47, 1769472
    buffer_load_dwordx4 v11, s[20:23], s50 offen lds
    s_add_u32 m0, s44, 12288
    s_add_u32 s50, s42, 124032
    buffer_load_dwordx4 v3, s[8:11], s50 offen lds
    s_add_u32 m0, s44, 28672
    s_add_u32 s50, s45, 2396160
    buffer_load_dwordx4 v8, s[12:15], s50 offen lds
    s_waitcnt vmcnt(16)
    s_barrier

    s_waitcnt vmcnt(0)
    s_barrier

    v_add_f32 v24, v24, v28
    v_add_f32 v32, v32, v36
    v_add_f32 v25, v25, v29
    v_add_f32 v33, v33, v37
    v_add_f32 v26, v26, v30
    v_add_f32 v34, v34, v38
    v_add_f32 v27, v27, v31
    v_add_f32 v35, v35, v39
    v_permlane32_swap_b32 v24, v32
    v_permlane32_swap_b32 v25, v33
    v_permlane32_swap_b32 v26, v34
    v_permlane32_swap_b32 v27, v35
    v_add_f32 v24, v24, v32
    v_add_f32 v25, v25, v33
    v_add_f32 v26, v26, v34
    v_add_f32 v27, v27, v35
    s_nop 0
    v_permlane16_swap_b32 v24, v26
    v_permlane16_swap_b32 v25, v27
    v_add_f32 v24, v24, v26
    v_add_f32 v25, v25, v27
    s_nop 0
    v_add_f32_dpp v24, v24, v24 row_ror:8 row_mask:0xf bank_mask:0xf
    v_add_f32_dpp v25, v25, v25 row_ror:8 row_mask:0xf bank_mask:0xf
    ds_write_b32 v40, v20
    ds_write_b32 v40, v21 offset:512
    ds_write_b64 v41, v[24:25] offset:1024
    s_waitcnt lgkmcnt(0)
    s_barrier

    v_lshlrev_b32 v3, 4, v2
    s_setprio 3
    s_cmp_lt_u32 s32, 8
    s_cbranch_scc1 MK_PZ_END
    s_lshl_b32 s54, s36, 2
    s_add_u32 s54, s54, s40
    s_lshl_b32 s57, s54, 12
    s_add_u32 s57, s57, 0x17fc000
    s_sub_u32 s58, s32, 8
    s_mul_i32 s53, s40, 24576
    s_add_u32 s53, s53, 12288
    v_mul_u32_u24 v60, 72, v6
    v_lshl_add_u32 v60, v7, 3, v60
    v_add_u32 v60, s53, v60
    v_bfe_u32 v61, v2, 2, 2
    v_lshl_add_u32 v61, v7, 3, v61
    v_mul_u32_u24 v61, 72, v61
    v_bfe_u32 v62, v2, 4, 1
    v_lshl_add_u32 v61, v62, 5, v61
    v_and_b32 v62, 3, v2
    v_lshl_add_u32 v61, v62, 3, v61
    v_add_u32 v61, s53, v61
    s_lshl_b32 s55, s54, 1
    s_lshl_b32 s56, s58, 7
    s_add_u32 s55, s55, s56
    s_mul_i32 s55, s55, 3072
    s_add_u32 s56, s55, 0xd80000
    s_mul_i32 s53, s40, 24576
    v_add_u32 v62, s53, v3
    s_lshl_b32 s53, s40, 2
    s_add_u32 s53, s53, 162960
    v_mov_b32 v63, s53
MK_PZ_W:
    s_sleep 2
    ds_read_b32 v16, v63
    s_waitcnt lgkmcnt(0)
    v_cmp_eq_u32 vcc, 0, v16
    s_cbranch_vccnz MK_PZ_W
    ds_read_b128 v[80:83], v62 offset:0
    ds_read_b128 v[84:87], v62 offset:1024
    ds_read_b128 v[88:91], v62 offset:2048
    ds_read_b128 v[92:95], v62 offset:3072
    ds_read_b128 v[96:99], v62 offset:4096
    ds_read_b128 v[100:103], v62 offset:5120
    ds_read_b128 v[104:107], v62 offset:6144
    ds_read_b128 v[108:111], v62 offset:7168
    ds_read_b128 v[112:115], v62 offset:8192
    ds_read_b128 v[116:119], v62 offset:9216
    ds_read_b128 v[120:123], v62 offset:10240
    ds_read_b128 v[124:127], v62 offset:11264
    s_mov_b32 s59, 0
MK_B_GP:
    buffer_load_dwordx4 v[16:19], v3, s[16:19], s57 offen offset:0 sc1
    buffer_load_dwordx4 v[20:23], v3, s[16:19], s57 offen offset:1024 sc1
    buffer_load_dwordx4 v[24:27], v3, s[16:19], s57 offen offset:2048 sc1
    buffer_load_dwordx4 v[28:31], v3, s[16:19], s57 offen offset:3072 sc1
    s_waitcnt vmcnt(0)
    v_xor_b32 v17, s86, v17
    v_xor_b32 v19, s86, v19
    v_xor_b32 v21, s86, v21
    v_xor_b32 v23, s86, v23
    v_xor_b32 v25, s86, v25
    v_xor_b32 v27, s86, v27
    v_xor_b32 v29, s86, v29
    v_xor_b32 v31, s86, v31
    v_or3_b32 v17, v17, v19, v21
    v_or3_b32 v23, v23, v25, v27
    v_or3_b32 v17, v17, v29, v31
    v_or_b32 v17, v17, v23
    v_cmp_ne_u32 vcc, 0, v17
    s_cbranch_vccz MK_B_GOK
    s_sleep 6
    s_add_u32 s59, s59, 1
    s_cmp_lt_u32 s59, 200000
    s_cbranch_scc1 MK_B_GP
MK_B_GOK:

    s_waitcnt lgkmcnt(0)
    s_setprio 3
    v_add_f32 v16, v16, v20
    v_add_f32 v17, v18, v22
    v_add_f32 v24, v24, v28
    v_add_f32 v25, v26, v30
    v_add_f32 v16, v16, v24
    v_add_f32 v17, v17, v25
    v_mov_b32 v18, v16
    v_mov_b32 v19, v17
    s_nop 0
    v_permlane32_swap_b32 v16, v18
    v_permlane32_swap_b32 v17, v19
    v_add_f32 v16, v16, v18
    v_add_f32 v17, v17, v19
    v_mul_f32 v16, 0xbaaaaaab, v16
    v_mul_f32 v17, 0x3aaaaaab, v17
    v_fma_f32 v17, -v16, v16, v17
    v_max_f32 v17, 0, v17
    v_add_f32 v17, 0x3727c5ac, v17
    v_rsq_f32 v17, v17
    s_waitcnt lgkmcnt(0)
    v_mul_f32 v16, v16, v17
    v_fma_f32 v80, v80, v17, v16
    v_fma_f32 v81, v81, v17, v16
    v_fma_f32 v82, v82, v17, v16
    v_fma_f32 v83, v83, v17, v16
    v_fma_f32 v84, v84, v17, v16
    v_fma_f32 v85, v85, v17, v16
    v_fma_f32 v86, v86, v17, v16
    v_fma_f32 v87, v87, v17, v16
    v_fma_f32 v88, v88, v17, v16
    v_fma_f32 v89, v89, v17, v16
    v_fma_f32 v90, v90, v17, v16
    v_fma_f32 v91, v91, v17, v16
    v_fma_f32 v92, v92, v17, v16
    v_fma_f32 v93, v93, v17, v16
    v_fma_f32 v94, v94, v17, v16
    v_fma_f32 v95, v95, v17, v16
    v_cvt_pk_bf16_f32 v80, v80, v81
    v_cvt_pk_bf16_f32 v81, v82, v83
    v_cvt_pk_bf16_f32 v82, v84, v85
    v_cvt_pk_bf16_f32 v83, v86, v87
    v_cvt_pk_bf16_f32 v84, v88, v89
    v_cvt_pk_bf16_f32 v85, v90, v91
    v_cvt_pk_bf16_f32 v86, v92, v93
    v_cvt_pk_bf16_f32 v87, v94, v95
    ds_write_b64 v60, v[80:81] offset:0
    ds_write_b64 v60, v[82:83] offset:16
    ds_write_b64 v60, v[84:85] offset:32
    ds_write_b64 v60, v[86:87] offset:48
    ds_read_b64_tr_b16 v[20:21], v61 offset:0
    ds_read_b64_tr_b16 v[22:23], v61 offset:288
    ds_read_b64_tr_b16 v[24:25], v61 offset:1152
    ds_read_b64_tr_b16 v[26:27], v61 offset:1440
    v_fma_f32 v96, v96, v17, v16
    v_fma_f32 v97, v97, v17, v16
    v_fma_f32 v98, v98, v17, v16
    v_fma_f32 v99, v99, v17, v16
    v_fma_f32 v100, v100, v17, v16
    v_fma_f32 v101, v101, v17, v16
    v_fma_f32 v102, v102, v17, v16
    v_fma_f32 v103, v103, v17, v16
    v_fma_f32 v104, v104, v17, v16
    v_fma_f32 v105, v105, v17, v16
    v_fma_f32 v106, v106, v17, v16
    v_fma_f32 v107, v107, v17, v16
    v_fma_f32 v108, v108, v17, v16
    v_fma_f32 v109, v109, v17, v16
    v_fma_f32 v110, v110, v17, v16
    v_fma_f32 v111, v111, v17, v16
    v_cvt_pk_bf16_f32 v96, v96, v97
    v_cvt_pk_bf16_f32 v97, v98, v99
    v_cvt_pk_bf16_f32 v98, v100, v101
    v_cvt_pk_bf16_f32 v99, v102, v103
    v_cvt_pk_bf16_f32 v100, v104, v105
    v_cvt_pk_bf16_f32 v101, v106, v107
    v_cvt_pk_bf16_f32 v102, v108, v109
    v_cvt_pk_bf16_f32 v103, v110, v111
    ds_write_b64 v60, v[96:97] offset:0
    ds_write_b64 v60, v[98:99] offset:16
    ds_write_b64 v60, v[100:101] offset:32
    ds_write_b64 v60, v[102:103] offset:48
    ds_read_b64_tr_b16 v[28:29], v61 offset:0
    ds_read_b64_tr_b16 v[30:31], v61 offset:288
    ds_read_b64_tr_b16 v[32:33], v61 offset:1152
    ds_read_b64_tr_b16 v[34:35], v61 offset:1440
    v_fma_f32 v112, v112, v17, v16
    v_fma_f32 v113, v113, v17, v16
    v_fma_f32 v114, v114, v17, v16
    v_fma_f32 v115, v115, v17, v16
    v_fma_f32 v116, v116, v17, v16
    v_fma_f32 v117, v117, v17, v16
    v_fma_f32 v118, v118, v17, v16
    v_fma_f32 v119, v119, v17, v16
    v_fma_f32 v120, v120, v17, v16
    v_fma_f32 v121, v121, v17, v16
    v_fma_f32 v122, v122, v17, v16
    v_fma_f32 v123, v123, v17, v16
    v_fma_f32 v124, v124, v17, v16
    v_fma_f32 v125, v125, v17, v16
    v_fma_f32 v126, v126, v17, v16
    v_fma_f32 v127, v127, v17, v16
    v_cvt_pk_bf16_f32 v112, v112, v113
    v_cvt_pk_bf16_f32 v113, v114, v115
    v_cvt_pk_bf16_f32 v114, v116, v117
    v_cvt_pk_bf16_f32 v115, v118, v119
    v_cvt_pk_bf16_f32 v116, v120, v121
    v_cvt_pk_bf16_f32 v117, v122, v123
    v_cvt_pk_bf16_f32 v118, v124, v125
    v_cvt_pk_bf16_f32 v119, v126, v127
    ds_write_b64 v60, v[112:113] offset:0
    ds_write_b64 v60, v[114:115] offset:16
    ds_write_b64 v60, v[116:117] offset:32
    ds_write_b64 v60, v[118:119] offset:48
    ds_read_b64_tr_b16 v[36:37], v61 offset:0
    ds_read_b64_tr_b16 v[38:39], v61 offset:288
    ds_read_b64_tr_b16 v[40:41], v61 offset:1152
    ds_read_b64_tr_b16 v[42:43], v61 offset:1440
    s_waitcnt lgkmcnt(15)
    buffer_store_dwordx4 v[20:23], v3, s[16:19], s56 offen sc1
    buffer_store_dwordx4 v[24:27], v3, s[16:19], s56 offen offset:3072 sc1
    s_add_u32 s56, s56, 1024
    s_waitcnt lgkmcnt(8)
    buffer_store_dwordx4 v[28:31], v3, s[16:19], s56 offen sc1
    buffer_store_dwordx4 v[32:35], v3, s[16:19], s56 offen offset:3072 sc1
    s_add_u32 s56, s56, 1024
    s_waitcnt lgkmcnt(0)
    buffer_store_dwordx4 v[36:39], v3, s[16:19], s56 offen sc1
    buffer_store_dwordx4 v[40:43], v3, s[16:19], s56 offen offset:3072 sc1
    s_add_u32 s56, s56, 1024
    s_setprio 3
    s_waitcnt vmcnt(0)
    s_mov_b64 exec, 1
    v_mov_b32 v16, 162828
    v_mov_b32 v17, 1
    ds_add_rtn_u32 v17, v16, v17
    s_waitcnt lgkmcnt(0)
    v_readfirstlane_b32 s50, v17
    s_nop 0
    s_cmp_lg_u32 s50, 3
    s_cbranch_scc1 MK_B_NOS4
    s_lshl_b32 s50, s58, 5
    s_add_u32 s50, s50, s36
    s_lshl_b32 s50, s50, 2
    s_add_u32 s50, s50, 0x1844000
    s_mov_b64 exec, 0xff
    v_mov_b32 v16, s86
    v_lshlrev_b32 v17, 10, v2
    buffer_store_dword v16, v17, s[16:19], s50 offen sc1
MK_B_NOS4:
    s_mov_b64 exec, -1

MK_PZ_END:
    v_mov_b32 v13, 162816
    v_mov_b32 v14, 1
    s_mul_i32 s41, s38, 163840
    s_mul_i32 s42, s40, 5120
    s_add_u32 s41, s41, s42
    s_add_u32 s41, s41, 0x280000
    s_mul_i32 s42, s40, 5376
    s_add_u32 s42, s42, 98304
    s_mov_b32 s8, s74
    s_mov_b32 s9, s75
    s_mov_b32 s10, 0x800000
    s_mov_b32 s11, 0x00020000
    s_mov_b32 s12, s76
    s_mov_b32 s13, s77
    s_mov_b32 s14, 0x1000
    s_mov_b32 s15, 0x00020000
    v_lshrrev_b32 v8, 3, v2
    v_lshlrev_b32 v8, 12, v8
    v_lshrrev_b32 v9, 4, v2
    v_and_b32 v10, 7, v2
    v_xor_b32 v9, v9, v10
    v_lshl_add_u32 v4, v9, 4, v8
    v_xor_b32 v5, 64, v4
    s_lshl_b32 s44, s38, 18
    s_lshl_b32 s45, s40, 7
    s_add_u32 s44, s44, s45
    s_mul_i32 s45, s40, 24576
    s_mul_i32 s47, s39, 393216
    s_mul_i32 s48, s40, 12288
    s_add_u32 s47, s47, s48
    s_add_u32 s47, s47, 0xd80000
    s_add_u32 s50, s38, s39
    s_and_b32 s50, s50, 1
    s_xor_b32 s51, s50, 0
    s_mul_i32 s64, s51, 49152
    s_add_u32 s64, s64, s47
    s_lshl_b32 s70, s51, 9
    s_add_u32 s70, s70, s44
    s_xor_b32 s51, s50, 1
    s_mul_i32 s65, s51, 49152
    s_add_u32 s65, s65, s47
    s_lshl_b32 s71, s51, 9
    s_add_u32 s71, s71, s44
    s_xor_b32 s51, s50, 2
    s_mul_i32 s66, s51, 49152
    s_add_u32 s66, s66, s47
    s_lshl_b32 s72, s51, 9
    s_add_u32 s72, s72, s44
    s_xor_b32 s51, s50, 3
    s_mul_i32 s67, s51, 49152
    s_add_u32 s67, s67, s47
    s_lshl_b32 s73, s51, 9
    s_add_u32 s73, s73, s44
    v_bfe_u32 v12, v2, 1, 3
    v_xor_b32 v12, v12, v7
    v_lshlrev_b32 v12, 4, v12
    v_lshl_add_u32 v12, v6, 7, v12
    v_add_u32 v12, s45, v12
    v_xor_b32 v8, 0, v12
    v_xor_b32 v9, 32, v12
    v_xor_b32 v10, 64, v12
    v_xor_b32 v11, 96, v12
    s_mul_i32 s52, s40, 3
    s_add_u32 s52, s52, 0
    s_lshr_b32 s53, s52, 1
    s_and_b32 s54, s52, 1
    s_cmp_ge_u32 s53, 3
    s_cselect_b32 s55, 1, 0
    s_cselect_b32 s56, 3, 0
    s_sub_u32 s56, s53, s56
    s_lshl_b32 s57, s38, 1
    s_add_u32 s57, s57, s55
    s_mul_i32 s58, s39, 3
    s_add_u32 s58, s58, s56
    s_mul_i32 s59, s57, 24
    s_add_u32 s59, s59, s58
    s_lshl_b32 s59, s59, 1
    s_add_u32 s59, s59, s54
    s_lshl_b32 s59, s59, 10
    s_add_u32 s94, s59, 0x780000
    s_lshl_b32 s97, s57, 6
    s_mul_i32 s59, s57, 88
    s_add_u32 s59, s59, s58
    s_add_u32 s59, s59, 20
    s_lshl_b32 s59, s59, 10
    s_lshl_b32 s54, s54, 9
    s_add_u32 s59, s59, s54
    s_add_u32 s60, s59, 0x1080000
    s_mul_i32 s52, s40, 3
    s_add_u32 s52, s52, 1
    s_lshr_b32 s53, s52, 1
    s_and_b32 s54, s52, 1
    s_cmp_ge_u32 s53, 3
    s_cselect_b32 s55, 1, 0
    s_cselect_b32 s56, 3, 0
    s_sub_u32 s56, s53, s56
    s_lshl_b32 s57, s38, 1
    s_add_u32 s57, s57, s55
    s_mul_i32 s58, s39, 3
    s_add_u32 s58, s58, s56
    s_mul_i32 s59, s57, 24
    s_add_u32 s59, s59, s58
    s_lshl_b32 s59, s59, 1
    s_add_u32 s59, s59, s54
    s_lshl_b32 s59, s59, 10
    s_add_u32 s95, s59, 0x780000
    s_lshl_b32 s98, s57, 6
    s_mul_i32 s59, s57, 88
    s_add_u32 s59, s59, s58
    s_add_u32 s59, s59, 20
    s_lshl_b32 s59, s59, 10
    s_lshl_b32 s54, s54, 9
    s_add_u32 s59, s59, s54
    s_add_u32 s61, s59, 0x1080000
    s_mul_i32 s52, s40, 3
    s_add_u32 s52, s52, 2
    s_lshr_b32 s53, s52, 1
    s_and_b32 s54, s52, 1
    s_cmp_ge_u32 s53, 3
    s_cselect_b32 s55, 1, 0
    s_cselect_b32 s56, 3, 0
    s_sub_u32 s56, s53, s56
    s_lshl_b32 s57, s38, 1
    s_add_u32 s57, s57, s55
    s_mul_i32 s58, s39, 3
    s_add_u32 s58, s58, s56
    s_mul_i32 s59, s57, 24
    s_add_u32 s59, s59, s58
    s_lshl_b32 s59, s59, 1
    s_add_u32 s59, s59, s54
    s_lshl_b32 s59, s59, 10
    s_add_u32 s96, s59, 0x780000
    s_lshl_b32 s99, s57, 6
    s_mul_i32 s59, s57, 88
    s_add_u32 s59, s59, s58
    s_add_u32 s59, s59, 20
    s_lshl_b32 s59, s59, 10
    s_lshl_b32 s54, s54, 9
    s_add_u32 s59, s59, s54
    s_add_u32 s62, s59, 0x1080000
    v_mov_b32 v28, 162880
MK_UPG:
    ds_read_b128 v[24:27], v28
    s_waitcnt lgkmcnt(0)
    v_min_u32 v24, v24, v25
    v_min3_u32 v24, v24, v26, v27
    v_cmp_gt_u32 vcc, 1, v24
    s_cbranch_vccz MK_UPG_OK
    s_sleep 8
    s_branch MK_UPG
MK_UPG_OK:
    s_add_u32 m0, s45, 0
    s_add_u32 s50, s70, 0
    buffer_load_dwordx4 v4, s[8:11], s50 offen lds
    s_add_u32 m0, s45, 1024
    s_add_u32 s50, s70, 32768
    buffer_load_dwordx4 v5, s[8:11], s50 offen lds
    s_add_u32 m0, s45, 2048
    s_add_u32 s50, s70, 65536
    buffer_load_dwordx4 v4, s[8:11], s50 offen lds
    s_add_u32 m0, s45, 3072
    s_add_u32 s50, s70, 98304
    buffer_load_dwordx4 v5, s[8:11], s50 offen lds
    s_add_u32 m0, s45, 4096
    s_add_u32 s50, s70, 131072
    buffer_load_dwordx4 v4, s[8:11], s50 offen lds
    s_add_u32 m0, s45, 5120
    s_add_u32 s50, s70, 163840
    buffer_load_dwordx4 v5, s[8:11], s50 offen lds
    s_add_u32 m0, s45, 6144
    s_add_u32 s50, s70, 196608
    buffer_load_dwordx4 v4, s[8:11], s50 offen lds
    s_add_u32 m0, s45, 7168
    s_add_u32 s50, s70, 229376
    buffer_load_dwordx4 v5, s[8:11], s50 offen lds
    s_cmp_lg_u32 s40, 0
    s_cbranch_scc1 MK_S4P_OK
    v_and_b32 v16, 15, v2
    v_lshlrev_b32 v16, 2, v16
    s_lshl_b32 s51, s34, 10
    s_lshl_b32 s50, s39, 7
    s_add_u32 s51, s51, s50
    s_add_u32 s51, s51, 0x1844000
    s_mov_b32 s56, 0
MK_S4P:
    buffer_load_dword v17, v16, s[16:19], s51 offen sc1
    s_waitcnt vmcnt(0)
    v_cmp_ne_u32 vcc, s86, v17
    s_cbranch_vccz MK_S4P_OK
    s_add_u32 s56, s56, 1
    s_cmp_gt_u32 s56, 200000
    s_cbranch_scc1 MK_S4P_OK
    s_sleep 8
    s_branch MK_S4P
MK_S4P_OK:
    s_mov_b64 exec, 1
    ds_add_u32 v13, v14
MK_GS1:
    ds_read_b32 v15, v13
    s_waitcnt lgkmcnt(0)
    v_readfirstlane_b32 s50, v15
    s_nop 0
    s_cmp_ge_u32 s50, 4
    s_cbranch_scc1 MK_GSD1
    s_sleep 4
    s_branch MK_GS1
MK_GSD1:
    s_mov_b64 exec, -1

    s_setprio 0
    s_add_u32 s48, s64, 0
    buffer_load_dwordx4 v[112:115], v3, s[16:19], s48 offen offset:0 sc1
    buffer_load_dwordx4 v[116:119], v3, s[16:19], s48 offen offset:1024 sc1
    buffer_load_dwordx4 v[120:123], v3, s[16:19], s48 offen offset:2048 sc1
    s_add_u32 s48, s64, 3072
    buffer_load_dwordx4 v[124:127], v3, s[16:19], s48 offen offset:0 sc1
    buffer_load_dwordx4 v[128:131], v3, s[16:19], s48 offen offset:1024 sc1
    buffer_load_dwordx4 v[132:135], v3, s[16:19], s48 offen offset:2048 sc1
    s_add_u32 s48, s64, 6144
    buffer_load_dwordx4 v[136:139], v3, s[16:19], s48 offen offset:0 sc1
    buffer_load_dwordx4 v[140:143], v3, s[16:19], s48 offen offset:1024 sc1
    buffer_load_dwordx4 v[144:147], v3, s[16:19], s48 offen offset:2048 sc1
    s_add_u32 m0, s45, 8192
    s_add_u32 s50, s71, 0
    buffer_load_dwordx4 v4, s[8:11], s50 offen lds
    s_add_u32 m0, s45, 9216
    s_add_u32 s50, s71, 32768
    buffer_load_dwordx4 v5, s[8:11], s50 offen lds
    s_add_u32 m0, s45, 10240
    s_add_u32 s50, s71, 65536
    buffer_load_dwordx4 v4, s[8:11], s50 offen lds
    s_add_u32 m0, s45, 11264
    s_add_u32 s50, s71, 98304
    buffer_load_dwordx4 v5, s[8:11], s50 offen lds
    s_add_u32 m0, s45, 12288
    s_add_u32 s50, s71, 131072
    buffer_load_dwordx4 v4, s[8:11], s50 offen lds
    s_add_u32 m0, s45, 13312
    s_add_u32 s50, s71, 163840
    buffer_load_dwordx4 v5, s[8:11], s50 offen lds
    s_add_u32 m0, s45, 14336
    s_add_u32 s50, s71, 196608
    buffer_load_dwordx4 v4, s[8:11], s50 offen lds
    s_add_u32 m0, s45, 15360
    s_add_u32 s50, s71, 229376
    buffer_load_dwordx4 v5, s[8:11], s50 offen lds
    s_waitcnt vmcnt(17)
    ds_read_b128 v[148:151], v8 offset:0
    ds_read_b128 v[152:155], v8 offset:4096
    s_waitcnt vmcnt(14)
    s_waitcnt lgkmcnt(0)
    v_mfma_f32_32x32x16_bf16 v[16:31], v[112:115], v[148:151], 0
    ds_read_b128 v[156:159], v9 offset:0
    ds_read_b128 v[160:163], v9 offset:4096
    v_mfma_f32_32x32x16_bf16 v[64:79], v[112:115], v[152:155], 0
    s_add_u32 s48, s64, 9216
    buffer_load_dwordx4 v[112:115], v3, s[16:19], s48 offen offset:0 sc1
    v_mfma_f32_32x32x16_bf16 v[32:47], v[116:119], v[148:151], 0
    v_mfma_f32_32x32x16_bf16 v[80:95], v[116:119], v[152:155], 0
    buffer_load_dwordx4 v[116:119], v3, s[16:19], s48 offen offset:1024 sc1
    v_mfma_f32_32x32x16_bf16 v[48:63], v[120:123], v[148:151], 0
    v_mfma_f32_32x32x16_bf16 v[96:111], v[120:123], v[152:155], 0
    buffer_load_dwordx4 v[120:123], v3, s[16:19], s48 offen offset:2048 sc1
    s_waitcnt vmcnt(14)
    s_waitcnt lgkmcnt(0)
    v_mfma_f32_32x32x16_bf16 v[16:31], v[124:127], v[156:159], v[16:31]
    ds_read_b128 v[148:151], v10 offset:0
    ds_read_b128 v[152:155], v10 offset:4096
    v_mfma_f32_32x32x16_bf16 v[64:79], v[124:127], v[160:163], v[64:79]
    s_add_u32 s48, s65, 0
    buffer_load_dwordx4 v[124:127], v3, s[16:19], s48 offen offset:0 sc1
    v_mfma_f32_32x32x16_bf16 v[32:47], v[128:131], v[156:159], v[32:47]
    v_mfma_f32_32x32x16_bf16 v[80:95], v[128:131], v[160:163], v[80:95]
    buffer_load_dwordx4 v[128:131], v3, s[16:19], s48 offen offset:1024 sc1
    v_mfma_f32_32x32x16_bf16 v[48:63], v[132:135], v[156:159], v[48:63]
    v_mfma_f32_32x32x16_bf16 v[96:111], v[132:135], v[160:163], v[96:111]
    buffer_load_dwordx4 v[132:135], v3, s[16:19], s48 offen offset:2048 sc1
    s_waitcnt vmcnt(14)
    s_waitcnt lgkmcnt(0)
    v_mfma_f32_32x32x16_bf16 v[16:31], v[136:139], v[148:151], v[16:31]
    ds_read_b128 v[156:159], v11 offset:0
    ds_read_b128 v[160:163], v11 offset:4096
    v_mfma_f32_32x32x16_bf16 v[64:79], v[136:139], v[152:155], v[64:79]
    s_add_u32 s48, s65, 3072
    buffer_load_dwordx4 v[136:139], v3, s[16:19], s48 offen offset:0 sc1
    v_mfma_f32_32x32x16_bf16 v[32:47], v[140:143], v[148:151], v[32:47]
    v_mfma_f32_32x32x16_bf16 v[80:95], v[140:143], v[152:155], v[80:95]
    buffer_load_dwordx4 v[140:143], v3, s[16:19], s48 offen offset:1024 sc1
    v_mfma_f32_32x32x16_bf16 v[48:63], v[144:147], v[148:151], v[48:63]
    v_mfma_f32_32x32x16_bf16 v[96:111], v[144:147], v[152:155], v[96:111]
    buffer_load_dwordx4 v[144:147], v3, s[16:19], s48 offen offset:2048 sc1
    s_waitcnt vmcnt(6)
    s_waitcnt lgkmcnt(0)
    v_mfma_f32_32x32x16_bf16 v[16:31], v[112:115], v[156:159], v[16:31]
    ds_read_b128 v[148:151], v8 offset:8192
    ds_read_b128 v[152:155], v8 offset:12288
    s_add_u32 m0, s45, 0
    s_add_u32 s50, s72, 0
    buffer_load_dwordx4 v4, s[8:11], s50 offen lds
    v_mfma_f32_32x32x16_bf16 v[64:79], v[112:115], v[160:163], v[64:79]
    s_add_u32 s48, s65, 6144
    buffer_load_dwordx4 v[112:115], v3, s[16:19], s48 offen offset:0 sc1
    v_mfma_f32_32x32x16_bf16 v[32:47], v[116:119], v[156:159], v[32:47]
    s_add_u32 m0, s45, 1024
    s_add_u32 s50, s72, 32768
    buffer_load_dwordx4 v5, s[8:11], s50 offen lds
    v_mfma_f32_32x32x16_bf16 v[80:95], v[116:119], v[160:163], v[80:95]
    buffer_load_dwordx4 v[116:119], v3, s[16:19], s48 offen offset:1024 sc1
    v_mfma_f32_32x32x16_bf16 v[48:63], v[120:123], v[156:159], v[48:63]
    s_add_u32 m0, s45, 2048
    s_add_u32 s50, s72, 65536
    buffer_load_dwordx4 v4, s[8:11], s50 offen lds
    v_mfma_f32_32x32x16_bf16 v[96:111], v[120:123], v[160:163], v[96:111]
    buffer_load_dwordx4 v[120:123], v3, s[16:19], s48 offen offset:2048 sc1
    s_waitcnt vmcnt(9)
    s_waitcnt lgkmcnt(0)
    v_mfma_f32_32x32x16_bf16 v[16:31], v[124:127], v[148:151], v[16:31]
    ds_read_b128 v[156:159], v9 offset:8192
    ds_read_b128 v[160:163], v9 offset:12288
    s_add_u32 m0, s45, 3072
    s_add_u32 s50, s72, 98304
    buffer_load_dwordx4 v5, s[8:11], s50 offen lds
    v_mfma_f32_32x32x16_bf16 v[64:79], v[124:127], v[152:155], v[64:79]
    s_add_u32 s48, s65, 9216
    buffer_load_dwordx4 v[124:127], v3, s[16:19], s48 offen offset:0 sc1
    v_mfma_f32_32x32x16_bf16 v[32:47], v[128:131], v[148:151], v[32:47]
    s_add_u32 m0, s45, 4096
    s_add_u32 s50, s72, 131072
    buffer_load_dwordx4 v4, s[8:11], s50 offen lds
    v_mfma_f32_32x32x16_bf16 v[80:95], v[128:131], v[152:155], v[80:95]
    buffer_load_dwordx4 v[128:131], v3, s[16:19], s48 offen offset:1024 sc1
    v_mfma_f32_32x32x16_bf16 v[48:63], v[132:135], v[148:151], v[48:63]
    s_add_u32 m0, s45, 5120
    s_add_u32 s50, s72, 163840
    buffer_load_dwordx4 v5, s[8:11], s50 offen lds
    v_mfma_f32_32x32x16_bf16 v[96:111], v[132:135], v[152:155], v[96:111]
    buffer_load_dwordx4 v[132:135], v3, s[16:19], s48 offen offset:2048 sc1
    s_waitcnt vmcnt(12)
    s_waitcnt lgkmcnt(0)
    v_mfma_f32_32x32x16_bf16 v[16:31], v[136:139], v[156:159], v[16:31]
    ds_read_b128 v[148:151], v10 offset:8192
    ds_read_b128 v[152:155], v10 offset:12288
    s_add_u32 m0, s45, 6144
    s_add_u32 s50, s72, 196608
    buffer_load_dwordx4 v4, s[8:11], s50 offen lds
    v_mfma_f32_32x32x16_bf16 v[64:79], v[136:139], v[160:163], v[64:79]
    s_add_u32 s48, s66, 0
    buffer_load_dwordx4 v[136:139], v3, s[16:19], s48 offen offset:0 sc1
    v_mfma_f32_32x32x16_bf16 v[32:47], v[140:143], v[156:159], v[32:47]
    s_add_u32 m0, s45, 7168
    s_add_u32 s50, s72, 229376
    buffer_load_dwordx4 v5, s[8:11], s50 offen lds
    v_mfma_f32_32x32x16_bf16 v[80:95], v[140:143], v[160:163], v[80:95]
    buffer_load_dwordx4 v[140:143], v3, s[16:19], s48 offen offset:1024 sc1
    v_mfma_f32_32x32x16_bf16 v[48:63], v[144:147], v[156:159], v[48:63]
    v_mfma_f32_32x32x16_bf16 v[96:111], v[144:147], v[160:163], v[96:111]
    buffer_load_dwordx4 v[144:147], v3, s[16:19], s48 offen offset:2048 sc1
    s_waitcnt vmcnt(11)
    s_waitcnt lgkmcnt(0)
    v_mfma_f32_32x32x16_bf16 v[16:31], v[112:115], v[148:151], v[16:31]
    ds_read_b128 v[156:159], v11 offset:8192
    ds_read_b128 v[160:163], v11 offset:12288
    v_mfma_f32_32x32x16_bf16 v[64:79], v[112:115], v[152:155], v[64:79]
    s_add_u32 s48, s66, 3072
    buffer_load_dwordx4 v[112:115], v3, s[16:19], s48 offen offset:0 sc1
    v_mfma_f32_32x32x16_bf16 v[32:47], v[116:119], v[148:151], v[32:47]
    v_mfma_f32_32x32x16_bf16 v[80:95], v[116:119], v[152:155], v[80:95]
    buffer_load_dwordx4 v[116:119], v3, s[16:19], s48 offen offset:1024 sc1
    v_mfma_f32_32x32x16_bf16 v[48:63], v[120:123], v[148:151], v[48:63]
    v_mfma_f32_32x32x16_bf16 v[96:111], v[120:123], v[152:155], v[96:111]
    buffer_load_dwordx4 v[120:123], v3, s[16:19], s48 offen offset:2048 sc1
    s_waitcnt vmcnt(8)
    s_waitcnt lgkmcnt(0)
    v_mfma_f32_32x32x16_bf16 v[16:31], v[124:127], v[156:159], v[16:31]
    s_waitcnt vmcnt(5)
    ds_read_b128 v[148:151], v8 offset:0
    ds_read_b128 v[152:155], v8 offset:4096
    s_add_u32 m0, s45, 8192
    s_add_u32 s50, s73, 0
    buffer_load_dwordx4 v4, s[8:11], s50 offen lds
    v_mfma_f32_32x32x16_bf16 v[64:79], v[124:127], v[160:163], v[64:79]
    s_add_u32 s48, s66, 6144
    buffer_load_dwordx4 v[124:127], v3, s[16:19], s48 offen offset:0 sc1
    v_mfma_f32_32x32x16_bf16 v[32:47], v[128:131], v[156:159], v[32:47]
    s_add_u32 m0, s45, 9216
    s_add_u32 s50, s73, 32768
    buffer_load_dwordx4 v5, s[8:11], s50 offen lds
    v_mfma_f32_32x32x16_bf16 v[80:95], v[128:131], v[160:163], v[80:95]
    buffer_load_dwordx4 v[128:131], v3, s[16:19], s48 offen offset:1024 sc1
    v_mfma_f32_32x32x16_bf16 v[48:63], v[132:135], v[156:159], v[48:63]
    s_add_u32 m0, s45, 10240
    s_add_u32 s50, s73, 65536
    buffer_load_dwordx4 v4, s[8:11], s50 offen lds
    v_mfma_f32_32x32x16_bf16 v[96:111], v[132:135], v[160:163], v[96:111]
    buffer_load_dwordx4 v[132:135], v3, s[16:19], s48 offen offset:2048 sc1
    s_waitcnt vmcnt(9)
    s_waitcnt lgkmcnt(0)
    v_mfma_f32_32x32x16_bf16 v[16:31], v[136:139], v[148:151], v[16:31]
    ds_read_b128 v[156:159], v9 offset:0
    ds_read_b128 v[160:163], v9 offset:4096
    s_add_u32 m0, s45, 11264
    s_add_u32 s50, s73, 98304
    buffer_load_dwordx4 v5, s[8:11], s50 offen lds
    v_mfma_f32_32x32x16_bf16 v[64:79], v[136:139], v[152:155], v[64:79]
    s_add_u32 s48, s66, 9216
    buffer_load_dwordx4 v[136:139], v3, s[16:19], s48 offen offset:0 sc1
    v_mfma_f32_32x32x16_bf16 v[32:47], v[140:143], v[148:151], v[32:47]
    s_add_u32 m0, s45, 12288
    s_add_u32 s50, s73, 131072
    buffer_load_dwordx4 v4, s[8:11], s50 offen lds
    v_mfma_f32_32x32x16_bf16 v[80:95], v[140:143], v[152:155], v[80:95]
    buffer_load_dwordx4 v[140:143], v3, s[16:19], s48 offen offset:1024 sc1
    v_mfma_f32_32x32x16_bf16 v[48:63], v[144:147], v[148:151], v[48:63]
    s_add_u32 m0, s45, 13312
    s_add_u32 s50, s73, 163840
    buffer_load_dwordx4 v5, s[8:11], s50 offen lds
    v_mfma_f32_32x32x16_bf16 v[96:111], v[144:147], v[152:155], v[96:111]
    buffer_load_dwordx4 v[144:147], v3, s[16:19], s48 offen offset:2048 sc1
    s_waitcnt vmcnt(12)
    s_waitcnt lgkmcnt(0)
    v_mfma_f32_32x32x16_bf16 v[16:31], v[112:115], v[156:159], v[16:31]
    ds_read_b128 v[148:151], v10 offset:0
    ds_read_b128 v[152:155], v10 offset:4096
    s_add_u32 m0, s45, 14336
    s_add_u32 s50, s73, 196608
    buffer_load_dwordx4 v4, s[8:11], s50 offen lds
    v_mfma_f32_32x32x16_bf16 v[64:79], v[112:115], v[160:163], v[64:79]
    s_add_u32 s48, s67, 0
    buffer_load_dwordx4 v[112:115], v3, s[16:19], s48 offen offset:0 sc1
    v_mfma_f32_32x32x16_bf16 v[32:47], v[116:119], v[156:159], v[32:47]
    s_add_u32 m0, s45, 15360
    s_add_u32 s50, s73, 229376
    buffer_load_dwordx4 v5, s[8:11], s50 offen lds
    v_mfma_f32_32x32x16_bf16 v[80:95], v[116:119], v[160:163], v[80:95]
    buffer_load_dwordx4 v[116:119], v3, s[16:19], s48 offen offset:1024 sc1
    v_mfma_f32_32x32x16_bf16 v[48:63], v[120:123], v[156:159], v[48:63]
    v_mfma_f32_32x32x16_bf16 v[96:111], v[120:123], v[160:163], v[96:111]
    buffer_load_dwordx4 v[120:123], v3, s[16:19], s48 offen offset:2048 sc1
    s_waitcnt vmcnt(11)
    s_waitcnt lgkmcnt(0)
    v_mfma_f32_32x32x16_bf16 v[16:31], v[124:127], v[148:151], v[16:31]
    ds_read_b128 v[156:159], v11 offset:0
    ds_read_b128 v[160:163], v11 offset:4096
    v_mfma_f32_32x32x16_bf16 v[64:79], v[124:127], v[152:155], v[64:79]
    s_add_u32 s48, s67, 3072
    buffer_load_dwordx4 v[124:127], v3, s[16:19], s48 offen offset:0 sc1
    v_mfma_f32_32x32x16_bf16 v[32:47], v[128:131], v[148:151], v[32:47]
    v_mfma_f32_32x32x16_bf16 v[80:95], v[128:131], v[152:155], v[80:95]
    buffer_load_dwordx4 v[128:131], v3, s[16:19], s48 offen offset:1024 sc1
    v_mfma_f32_32x32x16_bf16 v[48:63], v[132:135], v[148:151], v[48:63]
    v_mfma_f32_32x32x16_bf16 v[96:111], v[132:135], v[152:155], v[96:111]
    buffer_load_dwordx4 v[132:135], v3, s[16:19], s48 offen offset:2048 sc1
    s_waitcnt vmcnt(8)
    s_waitcnt lgkmcnt(0)
    v_mfma_f32_32x32x16_bf16 v[16:31], v[136:139], v[156:159], v[16:31]
    s_waitcnt vmcnt(5)
    ds_read_b128 v[148:151], v8 offset:8192
    ds_read_b128 v[152:155], v8 offset:12288
    s_add_u32 m0, s45, 0
    s_add_u32 s50, s70, 2048
    buffer_load_dwordx4 v4, s[8:11], s50 offen lds
    v_mfma_f32_32x32x16_bf16 v[64:79], v[136:139], v[160:163], v[64:79]
    s_add_u32 s48, s67, 6144
    buffer_load_dwordx4 v[136:139], v3, s[16:19], s48 offen offset:0 sc1
    v_mfma_f32_32x32x16_bf16 v[32:47], v[140:143], v[156:159], v[32:47]
    s_add_u32 m0, s45, 1024
    s_add_u32 s50, s70, 34816
    buffer_load_dwordx4 v5, s[8:11], s50 offen lds
    v_mfma_f32_32x32x16_bf16 v[80:95], v[140:143], v[160:163], v[80:95]
    buffer_load_dwordx4 v[140:143], v3, s[16:19], s48 offen offset:1024 sc1
    v_mfma_f32_32x32x16_bf16 v[48:63], v[144:147], v[156:159], v[48:63]
    s_add_u32 m0, s45, 2048
    s_add_u32 s50, s70, 67584
    buffer_load_dwordx4 v4, s[8:11], s50 offen lds
    v_mfma_f32_32x32x16_bf16 v[96:111], v[144:147], v[160:163], v[96:111]
    buffer_load_dwordx4 v[144:147], v3, s[16:19], s48 offen offset:2048 sc1
    s_waitcnt vmcnt(9)
    s_waitcnt lgkmcnt(0)
    v_mfma_f32_32x32x16_bf16 v[16:31], v[112:115], v[148:151], v[16:31]
    ds_read_b128 v[156:159], v9 offset:8192
    ds_read_b128 v[160:163], v9 offset:12288
    s_add_u32 m0, s45, 3072
    s_add_u32 s50, s70, 100352
    buffer_load_dwordx4 v5, s[8:11], s50 offen lds
    v_mfma_f32_32x32x16_bf16 v[64:79], v[112:115], v[152:155], v[64:79]
    s_add_u32 s48, s67, 9216
    buffer_load_dwordx4 v[112:115], v3, s[16:19], s48 offen offset:0 sc1
    v_mfma_f32_32x32x16_bf16 v[32:47], v[116:119], v[148:151], v[32:47]
    s_add_u32 m0, s45, 4096
    s_add_u32 s50, s70, 133120
    buffer_load_dwordx4 v4, s[8:11], s50 offen lds
    v_mfma_f32_32x32x16_bf16 v[80:95], v[116:119], v[152:155], v[80:95]
    buffer_load_dwordx4 v[116:119], v3, s[16:19], s48 offen offset:1024 sc1
    v_mfma_f32_32x32x16_bf16 v[48:63], v[120:123], v[148:151], v[48:63]
    s_add_u32 m0, s45, 5120
    s_add_u32 s50, s70, 165888
    buffer_load_dwordx4 v5, s[8:11], s50 offen lds
    v_mfma_f32_32x32x16_bf16 v[96:111], v[120:123], v[152:155], v[96:111]
    buffer_load_dwordx4 v[120:123], v3, s[16:19], s48 offen offset:2048 sc1
    s_waitcnt vmcnt(12)
    s_waitcnt lgkmcnt(0)
    v_mfma_f32_32x32x16_bf16 v[16:31], v[124:127], v[156:159], v[16:31]
    ds_read_b128 v[148:151], v10 offset:8192
    ds_read_b128 v[152:155], v10 offset:12288
    s_add_u32 m0, s45, 6144
    s_add_u32 s50, s70, 198656
    buffer_load_dwordx4 v4, s[8:11], s50 offen lds
    v_mfma_f32_32x32x16_bf16 v[64:79], v[124:127], v[160:163], v[64:79]
    s_add_u32 s48, s64, 196608
    buffer_load_dwordx4 v[124:127], v3, s[16:19], s48 offen offset:0 sc1
    v_mfma_f32_32x32x16_bf16 v[32:47], v[128:131], v[156:159], v[32:47]
    s_add_u32 m0, s45, 7168
    s_add_u32 s50, s70, 231424
    buffer_load_dwordx4 v5, s[8:11], s50 offen lds
    v_mfma_f32_32x32x16_bf16 v[80:95], v[128:131], v[160:163], v[80:95]
    buffer_load_dwordx4 v[128:131], v3, s[16:19], s48 offen offset:1024 sc1
    v_mfma_f32_32x32x16_bf16 v[48:63], v[132:135], v[156:159], v[48:63]
    v_mfma_f32_32x32x16_bf16 v[96:111], v[132:135], v[160:163], v[96:111]
    buffer_load_dwordx4 v[132:135], v3, s[16:19], s48 offen offset:2048 sc1
    s_waitcnt vmcnt(11)
    s_waitcnt lgkmcnt(0)
    v_mfma_f32_32x32x16_bf16 v[16:31], v[136:139], v[148:151], v[16:31]
    ds_read_b128 v[156:159], v11 offset:8192
    ds_read_b128 v[160:163], v11 offset:12288
    v_mfma_f32_32x32x16_bf16 v[64:79], v[136:139], v[152:155], v[64:79]
    s_add_u32 s48, s64, 199680
    buffer_load_dwordx4 v[136:139], v3, s[16:19], s48 offen offset:0 sc1
    v_mfma_f32_32x32x16_bf16 v[32:47], v[140:143], v[148:151], v[32:47]
    v_mfma_f32_32x32x16_bf16 v[80:95], v[140:143], v[152:155], v[80:95]
    buffer_load_dwordx4 v[140:143], v3, s[16:19], s48 offen offset:1024 sc1
    v_mfma_f32_32x32x16_bf16 v[48:63], v[144:147], v[148:151], v[48:63]
    v_mfma_f32_32x32x16_bf16 v[96:111], v[144:147], v[152:155], v[96:111]
    buffer_load_dwordx4 v[144:147], v3, s[16:19], s48 offen offset:2048 sc1
    s_waitcnt vmcnt(8)
    s_waitcnt lgkmcnt(0)
    v_mfma_f32_32x32x16_bf16 v[16:31], v[112:115], v[156:159], v[16:31]
    s_waitcnt vmcnt(5)
    ds_read_b128 v[148:151], v8 offset:0
    ds_read_b128 v[152:155], v8 offset:4096
    s_add_u32 m0, s45, 8192
    s_add_u32 s50, s71, 2048
    buffer_load_dwordx4 v4, s[8:11], s50 offen lds
    v_mfma_f32_32x32x16_bf16 v[64:79], v[112:115], v[160:163], v[64:79]
    s_add_u32 s48, s64, 202752
    buffer_load_dwordx4 v[112:115], v3, s[16:19], s48 offen offset:0 sc1
    v_mfma_f32_32x32x16_bf16 v[32:47], v[116:119], v[156:159], v[32:47]
    s_add_u32 m0, s45, 9216
    s_add_u32 s50, s71, 34816
    buffer_load_dwordx4 v5, s[8:11], s50 offen lds
    v_mfma_f32_32x32x16_bf16 v[80:95], v[116:119], v[160:163], v[80:95]
    buffer_load_dwordx4 v[116:119], v3, s[16:19], s48 offen offset:1024 sc1
    v_mfma_f32_32x32x16_bf16 v[48:63], v[120:123], v[156:159], v[48:63]
    s_add_u32 m0, s45, 10240
    s_add_u32 s50, s71, 67584
    buffer_load_dwordx4 v4, s[8:11], s50 offen lds
    v_mfma_f32_32x32x16_bf16 v[96:111], v[120:123], v[160:163], v[96:111]
    buffer_load_dwordx4 v[120:123], v3, s[16:19], s48 offen offset:2048 sc1
    s_waitcnt vmcnt(9)
    s_waitcnt lgkmcnt(0)
    v_mfma_f32_32x32x16_bf16 v[16:31], v[124:127], v[148:151], v[16:31]
    ds_read_b128 v[156:159], v9 offset:0
    ds_read_b128 v[160:163], v9 offset:4096
    s_add_u32 m0, s45, 11264
    s_add_u32 s50, s71, 100352
    buffer_load_dwordx4 v5, s[8:11], s50 offen lds
    v_mfma_f32_32x32x16_bf16 v[64:79], v[124:127], v[152:155], v[64:79]
    s_add_u32 s48, s64, 205824
    buffer_load_dwordx4 v[124:127], v3, s[16:19], s48 offen offset:0 sc1
    v_mfma_f32_32x32x16_bf16 v[32:47], v[128:131], v[148:151], v[32:47]
    s_add_u32 m0, s45, 12288
    s_add_u32 s50, s71, 133120
    buffer_load_dwordx4 v4, s[8:11], s50 offen lds
    v_mfma_f32_32x32x16_bf16 v[80:95], v[128:131], v[152:155], v[80:95]
    buffer_load_dwordx4 v[128:131], v3, s[16:19], s48 offen offset:1024 sc1
    v_mfma_f32_32x32x16_bf16 v[48:63], v[132:135], v[148:151], v[48:63]
    s_add_u32 m0, s45, 13312
    s_add_u32 s50, s71, 165888
    buffer_load_dwordx4 v5, s[8:11], s50 offen lds
    v_mfma_f32_32x32x16_bf16 v[96:111], v[132:135], v[152:155], v[96:111]
    buffer_load_dwordx4 v[132:135], v3, s[16:19], s48 offen offset:2048 sc1
    s_setprio 3
    v_and_b32 v12, 7, v2
    v_lshlrev_b32 v12, 2, v12
    v_add_u32 v12, 162912, v12
MK_S7L:
    ds_read_b32 v164, v12
    s_waitcnt lgkmcnt(0)
    v_cmp_eq_u32 vcc, 0, v164
    s_cbranch_vccnz MK_S7L
    s_setprio 0
    s_waitcnt vmcnt(12)
    s_waitcnt lgkmcnt(0)
    v_mfma_f32_32x32x16_bf16 v[16:31], v[136:139], v[156:159], v[16:31]
    ds_read_b128 v[148:151], v10 offset:0
    ds_read_b128 v[152:155], v10 offset:4096
    s_add_u32 m0, s45, 14336
    s_add_u32 s50, s71, 198656
    buffer_load_dwordx4 v4, s[8:11], s50 offen lds
    v_mfma_f32_32x32x16_bf16 v[64:79], v[136:139], v[160:163], v[64:79]
    s_add_u32 s48, s65, 196608
    buffer_load_dwordx4 v[136:139], v3, s[16:19], s48 offen offset:0 sc1
    v_mfma_f32_32x32x16_bf16 v[32:47], v[140:143], v[156:159], v[32:47]
    s_add_u32 m0, s45, 15360
    s_add_u32 s50, s71, 231424
    buffer_load_dwordx4 v5, s[8:11], s50 offen lds
    v_mfma_f32_32x32x16_bf16 v[80:95], v[140:143], v[160:163], v[80:95]
    buffer_load_dwordx4 v[140:143], v3, s[16:19], s48 offen offset:1024 sc1
    v_mfma_f32_32x32x16_bf16 v[48:63], v[144:147], v[156:159], v[48:63]
    v_mfma_f32_32x32x16_bf16 v[96:111], v[144:147], v[160:163], v[96:111]
    buffer_load_dwordx4 v[144:147], v3, s[16:19], s48 offen offset:2048 sc1
    s_waitcnt vmcnt(11)
    s_waitcnt lgkmcnt(0)
    v_mfma_f32_32x32x16_bf16 v[16:31], v[112:115], v[148:151], v[16:31]
    ds_read_b128 v[156:159], v11 offset:0
    ds_read_b128 v[160:163], v11 offset:4096
    v_mfma_f32_32x32x16_bf16 v[64:79], v[112:115], v[152:155], v[64:79]
    s_add_u32 s48, s65, 199680
    buffer_load_dwordx4 v[112:115], v3, s[16:19], s48 offen offset:0 sc1
    v_mfma_f32_32x32x16_bf16 v[32:47], v[116:119], v[148:151], v[32:47]
    v_mfma_f32_32x32x16_bf16 v[80:95], v[116:119], v[152:155], v[80:95]
    buffer_load_dwordx4 v[116:119], v3, s[16:19], s48 offen offset:1024 sc1
    v_mfma_f32_32x32x16_bf16 v[48:63], v[120:123], v[148:151], v[48:63]
    v_mfma_f32_32x32x16_bf16 v[96:111], v[120:123], v[152:155], v[96:111]
    buffer_load_dwordx4 v[120:123], v3, s[16:19], s48 offen offset:2048 sc1
    s_waitcnt vmcnt(8)
    s_waitcnt lgkmcnt(0)
    v_mfma_f32_32x32x16_bf16 v[16:31], v[124:127], v[156:159], v[16:31]
    s_waitcnt vmcnt(5)
    ds_read_b128 v[148:151], v8 offset:8192
    ds_read_b128 v[152:155], v8 offset:12288
    s_add_u32 m0, s45, 0
    s_add_u32 s50, s72, 2048
    buffer_load_dwordx4 v4, s[8:11], s50 offen lds
    v_mfma_f32_32x32x16_bf16 v[64:79], v[124:127], v[160:163], v[64:79]
    s_add_u32 s48, s65, 202752
    buffer_load_dwordx4 v[124:127], v3, s[16:19], s48 offen offset:0 sc1
    v_mfma_f32_32x32x16_bf16 v[32:47], v[128:131], v[156:159], v[32:47]
    s_add_u32 m0, s45, 1024
    s_add_u32 s50, s72, 34816
    buffer_load_dwordx4 v5, s[8:11], s50 offen lds
    v_mfma_f32_32x32x16_bf16 v[80:95], v[128:131], v[160:163], v[80:95]
    buffer_load_dwordx4 v[128:131], v3, s[16:19], s48 offen offset:1024 sc1
    v_mfma_f32_32x32x16_bf16 v[48:63], v[132:135], v[156:159], v[48:63]
    s_add_u32 m0, s45, 2048
    s_add_u32 s50, s72, 67584
    buffer_load_dwordx4 v4, s[8:11], s50 offen lds
    v_mfma_f32_32x32x16_bf16 v[96:111], v[132:135], v[160:163], v[96:111]
    buffer_load_dwordx4 v[132:135], v3, s[16:19], s48 offen offset:2048 sc1
    s_waitcnt vmcnt(9)
    s_waitcnt lgkmcnt(0)
    v_mfma_f32_32x32x16_bf16 v[16:31], v[136:139], v[148:151], v[16:31]
    ds_read_b128 v[156:159], v9 offset:8192
    ds_read_b128 v[160:163], v9 offset:12288
    s_add_u32 m0, s45, 3072
    s_add_u32 s50, s72, 100352
    buffer_load_dwordx4 v5, s[8:11], s50 offen lds
    v_mfma_f32_32x32x16_bf16 v[64:79], v[136:139], v[152:155], v[64:79]
    s_add_u32 s48, s65, 205824
    buffer_load_dwordx4 v[136:139], v3, s[16:19], s48 offen offset:0 sc1
    v_mfma_f32_32x32x16_bf16 v[32:47], v[140:143], v[148:151], v[32:47]
    s_add_u32 m0, s45, 4096
    s_add_u32 s50, s72, 133120
    buffer_load_dwordx4 v4, s[8:11], s50 offen lds
    v_mfma_f32_32x32x16_bf16 v[80:95], v[140:143], v[152:155], v[80:95]
    buffer_load_dwordx4 v[140:143], v3, s[16:19], s48 offen offset:1024 sc1
    v_mfma_f32_32x32x16_bf16 v[48:63], v[144:147], v[148:151], v[48:63]
    s_add_u32 m0, s45, 5120
    s_add_u32 s50, s72, 165888
    buffer_load_dwordx4 v5, s[8:11], s50 offen lds
    v_mfma_f32_32x32x16_bf16 v[96:111], v[144:147], v[152:155], v[96:111]
    buffer_load_dwordx4 v[144:147], v3, s[16:19], s48 offen offset:2048 sc1
    s_waitcnt vmcnt(12)
    s_waitcnt lgkmcnt(0)
    v_mfma_f32_32x32x16_bf16 v[16:31], v[112:115], v[156:159], v[16:31]
    ds_read_b128 v[148:151], v10 offset:8192
    ds_read_b128 v[152:155], v10 offset:12288
    s_add_u32 m0, s45, 6144
    s_add_u32 s50, s72, 198656
    buffer_load_dwordx4 v4, s[8:11], s50 offen lds
    v_mfma_f32_32x32x16_bf16 v[64:79], v[112:115], v[160:163], v[64:79]
    s_add_u32 s48, s66, 196608
    buffer_load_dwordx4 v[112:115], v3, s[16:19], s48 offen offset:0 sc1
    v_mfma_f32_32x32x16_bf16 v[32:47], v[116:119], v[156:159], v[32:47]
    s_add_u32 m0, s45, 7168
    s_add_u32 s50, s72, 231424
    buffer_load_dwordx4 v5, s[8:11], s50 offen lds
    v_mfma_f32_32x32x16_bf16 v[80:95], v[116:119], v[160:163], v[80:95]
    buffer_load_dwordx4 v[116:119], v3, s[16:19], s48 offen offset:1024 sc1
    v_mfma_f32_32x32x16_bf16 v[48:63], v[120:123], v[156:159], v[48:63]
    v_mfma_f32_32x32x16_bf16 v[96:111], v[120:123], v[160:163], v[96:111]
    buffer_load_dwordx4 v[120:123], v3, s[16:19], s48 offen offset:2048 sc1
    s_waitcnt vmcnt(11)
    s_waitcnt lgkmcnt(0)
    v_mfma_f32_32x32x16_bf16 v[16:31], v[124:127], v[148:151], v[16:31]
    ds_read_b128 v[156:159], v11 offset:8192
    ds_read_b128 v[160:163], v11 offset:12288
    v_mfma_f32_32x32x16_bf16 v[64:79], v[124:127], v[152:155], v[64:79]
    s_add_u32 s48, s66, 199680
    buffer_load_dwordx4 v[124:127], v3, s[16:19], s48 offen offset:0 sc1
    v_mfma_f32_32x32x16_bf16 v[32:47], v[128:131], v[148:151], v[32:47]
    v_mfma_f32_32x32x16_bf16 v[80:95], v[128:131], v[152:155], v[80:95]
    buffer_load_dwordx4 v[128:131], v3, s[16:19], s48 offen offset:1024 sc1
    v_mfma_f32_32x32x16_bf16 v[48:63], v[132:135], v[148:151], v[48:63]
    v_mfma_f32_32x32x16_bf16 v[96:111], v[132:135], v[152:155], v[96:111]
    buffer_load_dwordx4 v[132:135], v3, s[16:19], s48 offen offset:2048 sc1
    s_waitcnt vmcnt(8)
    s_waitcnt lgkmcnt(0)
    v_mfma_f32_32x32x16_bf16 v[16:31], v[136:139], v[156:159], v[16:31]
    s_waitcnt vmcnt(5)
    ds_read_b128 v[148:151], v8 offset:0
    ds_read_b128 v[152:155], v8 offset:4096
    s_add_u32 m0, s45, 8192
    s_add_u32 s50, s73, 2048
    buffer_load_dwordx4 v4, s[8:11], s50 offen lds
    v_mfma_f32_32x32x16_bf16 v[64:79], v[136:139], v[160:163], v[64:79]
    s_add_u32 s48, s66, 202752
    buffer_load_dwordx4 v[136:139], v3, s[16:19], s48 offen offset:0 sc1
    v_mfma_f32_32x32x16_bf16 v[32:47], v[140:143], v[156:159], v[32:47]
    s_add_u32 m0, s45, 9216
    s_add_u32 s50, s73, 34816
    buffer_load_dwordx4 v5, s[8:11], s50 offen lds
    v_mfma_f32_32x32x16_bf16 v[80:95], v[140:143], v[160:163], v[80:95]
    buffer_load_dwordx4 v[140:143], v3, s[16:19], s48 offen offset:1024 sc1
    v_mfma_f32_32x32x16_bf16 v[48:63], v[144:147], v[156:159], v[48:63]
    s_add_u32 m0, s45, 10240
    s_add_u32 s50, s73, 67584
    buffer_load_dwordx4 v4, s[8:11], s50 offen lds
    v_mfma_f32_32x32x16_bf16 v[96:111], v[144:147], v[160:163], v[96:111]
    buffer_load_dwordx4 v[144:147], v3, s[16:19], s48 offen offset:2048 sc1
    s_waitcnt vmcnt(9)
    s_waitcnt lgkmcnt(0)
    v_mfma_f32_32x32x16_bf16 v[16:31], v[112:115], v[148:151], v[16:31]
    ds_read_b128 v[156:159], v9 offset:0
    ds_read_b128 v[160:163], v9 offset:4096
    s_add_u32 m0, s45, 11264
    s_add_u32 s50, s73, 100352
    buffer_load_dwordx4 v5, s[8:11], s50 offen lds
    v_mfma_f32_32x32x16_bf16 v[64:79], v[112:115], v[152:155], v[64:79]
    s_add_u32 s48, s66, 205824
    buffer_load_dwordx4 v[112:115], v3, s[16:19], s48 offen offset:0 sc1
    v_mfma_f32_32x32x16_bf16 v[32:47], v[116:119], v[148:151], v[32:47]
    s_add_u32 m0, s45, 12288
    s_add_u32 s50, s73, 133120
    buffer_load_dwordx4 v4, s[8:11], s50 offen lds
    v_mfma_f32_32x32x16_bf16 v[80:95], v[116:119], v[152:155], v[80:95]
    buffer_load_dwordx4 v[116:119], v3, s[16:19], s48 offen offset:1024 sc1
    v_mfma_f32_32x32x16_bf16 v[48:63], v[120:123], v[148:151], v[48:63]
    s_add_u32 m0, s45, 13312
    s_add_u32 s50, s73, 165888
    buffer_load_dwordx4 v5, s[8:11], s50 offen lds
    v_mfma_f32_32x32x16_bf16 v[96:111], v[120:123], v[152:155], v[96:111]
    buffer_load_dwordx4 v[120:123], v3, s[16:19], s48 offen offset:2048 sc1
    s_waitcnt vmcnt(12)
    s_waitcnt lgkmcnt(0)
    v_mfma_f32_32x32x16_bf16 v[16:31], v[124:127], v[156:159], v[16:31]
    ds_read_b128 v[148:151], v10 offset:0
    ds_read_b128 v[152:155], v10 offset:4096
    s_add_u32 m0, s45, 14336
    s_add_u32 s50, s73, 198656
    buffer_load_dwordx4 v4, s[8:11], s50 offen lds
    v_mfma_f32_32x32x16_bf16 v[64:79], v[124:127], v[160:163], v[64:79]
    s_add_u32 s48, s67, 196608
    buffer_load_dwordx4 v[124:127], v3, s[16:19], s48 offen offset:0 sc1
    v_mfma_f32_32x32x16_bf16 v[32:47], v[128:131], v[156:159], v[32:47]
    s_add_u32 m0, s45, 15360
    s_add_u32 s50, s73, 231424
    buffer_load_dwordx4 v5, s[8:11], s50 offen lds
    v_mfma_f32_32x32x16_bf16 v[80:95], v[128:131], v[160:163], v[80:95]
    buffer_load_dwordx4 v[128:131], v3, s[16:19], s48 offen offset:1024 sc1
    v_mfma_f32_32x32x16_bf16 v[48:63], v[132:135], v[156:159], v[48:63]
    v_mfma_f32_32x32x16_bf16 v[96:111], v[132:135], v[160:163], v[96:111]
    buffer_load_dwordx4 v[132:135], v3, s[16:19], s48 offen offset:2048 sc1
    s_setprio 3
    s_bfe_u32 s50, s35, 0x10001
    s_lshl_b32 s50, s50, 4
    s_add_u32 s50, s50, s39
    s_lshl_b32 s50, s50, 2
    s_add_u32 s50, s50, 32768
    s_lshl_b32 s63, s34, 10
    s_add_u32 s63, s63, 0x1842000
    s_lshl_b32 s51, s39, 7
    v_lshl_add_u32 v12, v6, 2, s51
    s_mov_b32 exec_lo, 0
    v_mov_b32 v12, s50
    s_mov_b32 exec_lo, -1
    buffer_load_dword v15, v12, s[16:19], s63 offen sc1
    s_setprio 0
    s_waitcnt vmcnt(12)
    s_waitcnt lgkmcnt(0)
    v_mfma_f32_32x32x16_bf16 v[16:31], v[136:139], v[148:151], v[16:31]
    ds_read_b128 v[156:159], v11 offset:0
    ds_read_b128 v[160:163], v11 offset:4096
    v_mfma_f32_32x32x16_bf16 v[64:79], v[136:139], v[152:155], v[64:79]
    s_add_u32 s48, s67, 199680
    buffer_load_dwordx4 v[136:139], v3, s[16:19], s48 offen offset:0 sc1
    v_mfma_f32_32x32x16_bf16 v[32:47], v[140:143], v[148:151], v[32:47]
    v_mfma_f32_32x32x16_bf16 v[80:95], v[140:143], v[152:155], v[80:95]
    buffer_load_dwordx4 v[140:143], v3, s[16:19], s48 offen offset:1024 sc1
    v_mfma_f32_32x32x16_bf16 v[48:63], v[144:147], v[148:151], v[48:63]
    v_mfma_f32_32x32x16_bf16 v[96:111], v[144:147], v[152:155], v[96:111]
    buffer_load_dwordx4 v[144:147], v3, s[16:19], s48 offen offset:2048 sc1
    s_waitcnt vmcnt(9)
    s_waitcnt lgkmcnt(0)
    v_mfma_f32_32x32x16_bf16 v[16:31], v[112:115], v[156:159], v[16:31]
    s_waitcnt vmcnt(6)
    ds_read_b128 v[148:151], v8 offset:8192
    ds_read_b128 v[152:155], v8 offset:12288
    v_mfma_f32_32x32x16_bf16 v[64:79], v[112:115], v[160:163], v[64:79]
    s_add_u32 s48, s67, 202752
    buffer_load_dwordx4 v[112:115], v3, s[16:19], s48 offen offset:0 sc1
    v_mfma_f32_32x32x16_bf16 v[32:47], v[116:119], v[156:159], v[32:47]
    v_mfma_f32_32x32x16_bf16 v[80:95], v[116:119], v[160:163], v[80:95]
    buffer_load_dwordx4 v[116:119], v3, s[16:19], s48 offen offset:1024 sc1
    v_mfma_f32_32x32x16_bf16 v[48:63], v[120:123], v[156:159], v[48:63]
    v_mfma_f32_32x32x16_bf16 v[96:111], v[120:123], v[160:163], v[96:111]
    buffer_load_dwordx4 v[120:123], v3, s[16:19], s48 offen offset:2048 sc1
    s_waitcnt vmcnt(7)
    s_waitcnt lgkmcnt(0)
    v_mfma_f32_32x32x16_bf16 v[16:31], v[124:127], v[148:151], v[16:31]
    ds_read_b128 v[156:159], v9 offset:8192
    ds_read_b128 v[160:163], v9 offset:12288
    v_mfma_f32_32x32x16_bf16 v[64:79], v[124:127], v[152:155], v[64:79]
    s_add_u32 s48, s67, 205824
    buffer_load_dwordx4 v[124:127], v3, s[16:19], s48 offen offset:0 sc1
    v_mfma_f32_32x32x16_bf16 v[32:47], v[128:131], v[148:151], v[32:47]
    v_mfma_f32_32x32x16_bf16 v[80:95], v[128:131], v[152:155], v[80:95]
    buffer_load_dwordx4 v[128:131], v3, s[16:19], s48 offen offset:1024 sc1
    v_mfma_f32_32x32x16_bf16 v[48:63], v[132:135], v[148:151], v[48:63]
    v_mfma_f32_32x32x16_bf16 v[96:111], v[132:135], v[152:155], v[96:111]
    buffer_load_dwordx4 v[132:135], v3, s[16:19], s48 offen offset:2048 sc1
    s_waitcnt vmcnt(6)
    s_waitcnt lgkmcnt(0)
    v_mfma_f32_32x32x16_bf16 v[16:31], v[136:139], v[156:159], v[16:31]
    ds_read_b128 v[148:151], v10 offset:8192
    ds_read_b128 v[152:155], v10 offset:12288
    v_mfma_f32_32x32x16_bf16 v[64:79], v[136:139], v[160:163], v[64:79]
    v_mfma_f32_32x32x16_bf16 v[32:47], v[140:143], v[156:159], v[32:47]
    v_mfma_f32_32x32x16_bf16 v[80:95], v[140:143], v[160:163], v[80:95]
    v_mfma_f32_32x32x16_bf16 v[48:63], v[144:147], v[156:159], v[48:63]
    v_mfma_f32_32x32x16_bf16 v[96:111], v[144:147], v[160:163], v[96:111]
    s_setprio 3
    v_cmp_ne_u32 vcc, s86, v15
    s_cbranch_vccz MK_S7P_OK
    s_mov_b32 s50, 0
MK_S7P:
    buffer_load_dword v15, v12, s[16:19], s63 offen sc1
    s_waitcnt vmcnt(0)
    v_cmp_ne_u32 vcc, s86, v15
    s_cbranch_vccz MK_S7P_OK
    s_add_u32 s50, s50, 1
    s_cmp_gt_u32 s50, 200000
    s_cbranch_scc1 MK_S7P_OK
    s_sleep 2
    s_branch MK_S7P
MK_S7P_OK:
    v_lshlrev_b32 v5, 1, v6
    buffer_load_dwordx4 v[136:139], v3, s[16:19], s94 offen sc1
    buffer_load_dwordx4 v[140:143], v3, s[16:19], s95 offen sc1
    buffer_load_dwordx4 v[144:147], v3, s[16:19], s96 offen sc1
    s_setprio 0
    s_waitcnt vmcnt(6)
    s_waitcnt lgkmcnt(0)
    v_mfma_f32_32x32x16_bf16 v[16:31], v[112:115], v[148:151], v[16:31]
    ds_read_b128 v[156:159], v11 offset:8192
    ds_read_b128 v[160:163], v11 offset:12288
    v_mfma_f32_32x32x16_bf16 v[64:79], v[112:115], v[152:155], v[64:79]
    v_mfma_f32_32x32x16_bf16 v[32:47], v[116:119], v[148:151], v[32:47]
    v_mfma_f32_32x32x16_bf16 v[80:95], v[116:119], v[152:155], v[80:95]
    v_mfma_f32_32x32x16_bf16 v[48:63], v[120:123], v[148:151], v[48:63]
    v_mfma_f32_32x32x16_bf16 v[96:111], v[120:123], v[152:155], v[96:111]
    buffer_load_ushort v112, v5, s[12:15], s97 offen
    buffer_load_ushort v113, v5, s[12:15], s98 offen
    buffer_load_ushort v114, v5, s[12:15], s99 offen
    s_waitcnt vmcnt(6)
    s_waitcnt lgkmcnt(0)
    v_mfma_f32_32x32x16_bf16 v[16:31], v[124:127], v[156:159], v[16:31]
    v_mfma_f32_32x32x16_bf16 v[64:79], v[124:127], v[160:163], v[64:79]
    v_mfma_f32_32x32x16_bf16 v[32:47], v[128:131], v[156:159], v[32:47]
    v_mfma_f32_32x32x16_bf16 v[80:95], v[128:131], v[160:163], v[80:95]
    v_mfma_f32_32x32x16_bf16 v[48:63], v[132:135], v[156:159], v[48:63]
    v_mfma_f32_32x32x16_bf16 v[96:111], v[132:135], v[160:163], v[96:111]

    s_setprio 3
    s_mul_i32 s50, s40, 24576
    v_add_u32 v4, s50, v3
    v_add_u32 v5, 49152, v3
    v_bfe_u32 v8, v2, 4, 1
    v_mul_u32_u24 v8, 45056, v8
    v_and_b32 v9, 15, v2
    v_lshl_add_u32 v8, v9, 4, v8
    v_lshl_add_u32 v8, v7, 8, v8
    s_setprio 0
    s_cmp_eq_u32 s40, 1
    s_cbranch_scc1 MK_EW1
    s_cmp_eq_u32 s40, 2
    s_cbranch_scc1 MK_EW2
    s_cmp_eq_u32 s40, 3
    s_cbranch_scc1 MK_EW3
    ds_write_b128 v4, v[40:43] offset:6144
    ds_write_b128 v4, v[44:47] offset:7168
    ds_write_b128 v4, v[48:51] offset:8192
    ds_write_b128 v4, v[52:55] offset:9216
    ds_write_b128 v4, v[56:59] offset:10240
    ds_write_b128 v4, v[60:63] offset:11264
    ds_write_b128 v4, v[64:67] offset:12288
    ds_write_b128 v4, v[68:71] offset:13312
    ds_write_b128 v4, v[72:75] offset:14336
    ds_write_b128 v4, v[76:79] offset:15360
    ds_write_b128 v4, v[80:83] offset:16384
    ds_write_b128 v4, v[84:87] offset:17408
    ds_write_b128 v4, v[88:91] offset:18432
    ds_write_b128 v4, v[92:95] offset:19456
    ds_write_b128 v4, v[96:99] offset:20480
    ds_write_b128 v4, v[100:103] offset:21504
    ds_write_b128 v4, v[104:107] offset:22528
    ds_write_b128 v4, v[108:111] offset:23552
    s_branch MK_EWD
MK_EW1:
    ds_write_b128 v4, v[16:19] offset:0
    ds_write_b128 v4, v[20:23] offset:1024
    ds_write_b128 v4, v[24:27] offset:2048
    ds_write_b128 v4, v[28:31] offset:3072
    ds_write_b128 v4, v[32:35] offset:4096
    ds_write_b128 v4, v[36:39] offset:5120
    ds_write_b128 v4, v[64:67] offset:12288
    ds_write_b128 v4, v[68:71] offset:13312
    ds_write_b128 v4, v[72:75] offset:14336
    ds_write_b128 v4, v[76:79] offset:15360
    ds_write_b128 v4, v[80:83] offset:16384
    ds_write_b128 v4, v[84:87] offset:17408
    ds_write_b128 v4, v[88:91] offset:18432
    ds_write_b128 v4, v[92:95] offset:19456
    ds_write_b128 v4, v[96:99] offset:20480
    ds_write_b128 v4, v[100:103] offset:21504
    ds_write_b128 v4, v[104:107] offset:22528
    ds_write_b128 v4, v[108:111] offset:23552
    s_branch MK_EWD
MK_EW2:
    ds_write_b128 v4, v[16:19] offset:0
    ds_write_b128 v4, v[20:23] offset:1024
    ds_write_b128 v4, v[24:27] offset:2048
    ds_write_b128 v4, v[28:31] offset:3072
    ds_write_b128 v4, v[32:35] offset:4096
    ds_write_b128 v4, v[36:39] offset:5120
    ds_write_b128 v4, v[40:43] offset:6144
    ds_write_b128 v4, v[44:47] offset:7168
    ds_write_b128 v4, v[48:51] offset:8192
    ds_write_b128 v4, v[52:55] offset:9216
    ds_write_b128 v4, v[56:59] offset:10240
    ds_write_b128 v4, v[60:63] offset:11264
    ds_write_b128 v4, v[88:91] offset:18432
    ds_write_b128 v4, v[92:95] offset:19456
    ds_write_b128 v4, v[96:99] offset:20480
    ds_write_b128 v4, v[100:103] offset:21504
    ds_write_b128 v4, v[104:107] offset:22528
    ds_write_b128 v4, v[108:111] offset:23552
    s_branch MK_EWD
MK_EW3:
    ds_write_b128 v4, v[16:19] offset:0
    ds_write_b128 v4, v[20:23] offset:1024
    ds_write_b128 v4, v[24:27] offset:2048
    ds_write_b128 v4, v[28:31] offset:3072
    ds_write_b128 v4, v[32:35] offset:4096
    ds_write_b128 v4, v[36:39] offset:5120
    ds_write_b128 v4, v[40:43] offset:6144
    ds_write_b128 v4, v[44:47] offset:7168
    ds_write_b128 v4, v[48:51] offset:8192
    ds_write_b128 v4, v[52:55] offset:9216
    ds_write_b128 v4, v[56:59] offset:10240
    ds_write_b128 v4, v[60:63] offset:11264
    ds_write_b128 v4, v[64:67] offset:12288
    ds_write_b128 v4, v[68:71] offset:13312
    ds_write_b128 v4, v[72:75] offset:14336
    ds_write_b128 v4, v[76:79] offset:15360
    ds_write_b128 v4, v[80:83] offset:16384
    ds_write_b128 v4, v[84:87] offset:17408
MK_EWD:
    s_setprio 3
    s_waitcnt vmcnt(0)
    s_waitcnt lgkmcnt(0)
    s_mov_b64 exec, 1
    ds_add_u32 v13, v14
MK_GS2:
    ds_read_b32 v15, v13
    s_waitcnt lgkmcnt(0)
    v_readfirstlane_b32 s50, v15
    s_nop 0
    s_cmp_ge_u32 s50, 8
    s_cbranch_scc1 MK_GSD2
    s_sleep 1
    s_branch MK_GS2
MK_GSD2:
    s_mov_b64 exec, -1

    s_setprio 3
    v_lshlrev_b32 v112, 16, v112
    v_lshlrev_b32 v113, 16, v113
    v_lshlrev_b32 v114, 16, v114
    s_cmp_eq_u32 s40, 1
    s_cbranch_scc1 MK_ER1
    s_cmp_eq_u32 s40, 2
    s_cbranch_scc1 MK_ER2
    s_cmp_eq_u32 s40, 3
    s_cbranch_scc1 MK_ER3
    ds_read_b128 v[40:43], v3 offset:24576
    ds_read_b128 v[44:47], v3 offset:25600
    ds_read_b128 v[64:67], v5 offset:0
    ds_read_b128 v[68:71], v5 offset:1024
    ds_read_b128 v[88:91], v5 offset:24576
    ds_read_b128 v[92:95], v5 offset:25600
    ds_read_b128 v[48:51], v3 offset:26624
    ds_read_b128 v[52:55], v3 offset:27648
    ds_read_b128 v[72:75], v5 offset:2048
    ds_read_b128 v[76:79], v5 offset:3072
    ds_read_b128 v[96:99], v5 offset:26624
    ds_read_b128 v[100:103], v5 offset:27648
    s_waitcnt lgkmcnt(6)
    ds_read_b128 v[56:59], v3 offset:28672
    ds_read_b128 v[60:63], v3 offset:29696
    ds_read_b128 v[80:83], v5 offset:4096
    ds_read_b128 v[84:87], v5 offset:5120
    ds_read_b128 v[104:107], v5 offset:28672
    ds_read_b128 v[108:111], v5 offset:29696
    v_add_f32 v16, v16, v112
    v_add_f32 v17, v17, v112
    v_add_f32 v18, v18, v112
    v_add_f32 v19, v19, v112
    v_add_f32 v20, v20, v112
    v_add_f32 v21, v21, v112
    v_add_f32 v22, v22, v112
    v_add_f32 v23, v23, v112
    s_waitcnt lgkmcnt(12)
    v_add_f32 v16, v16, v40
    v_add_f32 v64, v64, v88
    v_add_f32 v17, v17, v41
    v_add_f32 v65, v65, v89
    v_add_f32 v18, v18, v42
    v_add_f32 v66, v66, v90
    v_add_f32 v19, v19, v43
    v_add_f32 v67, v67, v91
    v_add_f32 v20, v20, v44
    v_add_f32 v68, v68, v92
    v_add_f32 v21, v21, v45
    v_add_f32 v69, v69, v93
    v_add_f32 v22, v22, v46
    v_add_f32 v70, v70, v94
    v_add_f32 v23, v23, v47
    v_add_f32 v71, v71, v95
    v_lshlrev_b32 v40, 16, v136
    v_and_b32 v41, 0xffff0000, v136
    v_lshlrev_b32 v42, 16, v137
    v_and_b32 v43, 0xffff0000, v137
    v_lshlrev_b32 v44, 16, v138
    v_and_b32 v45, 0xffff0000, v138
    v_lshlrev_b32 v46, 16, v139
    v_and_b32 v47, 0xffff0000, v139
    v_add_f32 v16, v16, v64
    v_add_f32 v17, v17, v65
    v_add_f32 v18, v18, v66
    v_add_f32 v19, v19, v67
    v_add_f32 v20, v20, v68
    v_add_f32 v21, v21, v69
    v_add_f32 v22, v22, v70
    v_add_f32 v23, v23, v71
    v_mul_f32 v16, v16, v40
    v_mul_f32 v17, v17, v41
    v_mul_f32 v18, v18, v42
    v_mul_f32 v19, v19, v43
    v_mul_f32 v20, v20, v44
    v_mul_f32 v21, v21, v45
    v_mul_f32 v22, v22, v46
    v_mul_f32 v23, v23, v47
    v_cvt_pk_bf16_f32 v16, v16, v17
    v_cvt_pk_bf16_f32 v17, v18, v19
    v_cvt_pk_bf16_f32 v18, v20, v21
    v_cvt_pk_bf16_f32 v19, v22, v23
    buffer_store_dwordx4 v[16:19], v8, s[16:19], s60 offen sc1
    v_add_f32 v24, v24, v113
    v_add_f32 v25, v25, v113
    v_add_f32 v26, v26, v113
    v_add_f32 v27, v27, v113
    v_add_f32 v28, v28, v113
    v_add_f32 v29, v29, v113
    v_add_f32 v30, v30, v113
    v_add_f32 v31, v31, v113
    s_waitcnt lgkmcnt(6)
    v_add_f32 v24, v24, v48
    v_add_f32 v72, v72, v96
    v_add_f32 v25, v25, v49
    v_add_f32 v73, v73, v97
    v_add_f32 v26, v26, v50
    v_add_f32 v74, v74, v98
    v_add_f32 v27, v27, v51
    v_add_f32 v75, v75, v99
    v_add_f32 v28, v28, v52
    v_add_f32 v76, v76, v100
    v_add_f32 v29, v29, v53
    v_add_f32 v77, v77, v101
    v_add_f32 v30, v30, v54
    v_add_f32 v78, v78, v102
    v_add_f32 v31, v31, v55
    v_add_f32 v79, v79, v103
    v_lshlrev_b32 v48, 16, v140
    v_and_b32 v49, 0xffff0000, v140
    v_lshlrev_b32 v50, 16, v141
    v_and_b32 v51, 0xffff0000, v141
    v_lshlrev_b32 v52, 16, v142
    v_and_b32 v53, 0xffff0000, v142
    v_lshlrev_b32 v54, 16, v143
    v_and_b32 v55, 0xffff0000, v143
    v_add_f32 v24, v24, v72
    v_add_f32 v25, v25, v73
    v_add_f32 v26, v26, v74
    v_add_f32 v27, v27, v75
    v_add_f32 v28, v28, v76
    v_add_f32 v29, v29, v77
    v_add_f32 v30, v30, v78
    v_add_f32 v31, v31, v79
    v_mul_f32 v24, v24, v48
    v_mul_f32 v25, v25, v49
    v_mul_f32 v26, v26, v50
    v_mul_f32 v27, v27, v51
    v_mul_f32 v28, v28, v52
    v_mul_f32 v29, v29, v53
    v_mul_f32 v30, v30, v54
    v_mul_f32 v31, v31, v55
    v_cvt_pk_bf16_f32 v24, v24, v25
    v_cvt_pk_bf16_f32 v25, v26, v27
    v_cvt_pk_bf16_f32 v26, v28, v29
    v_cvt_pk_bf16_f32 v27, v30, v31
    buffer_store_dwordx4 v[24:27], v8, s[16:19], s61 offen sc1
    v_add_f32 v32, v32, v114
    v_add_f32 v33, v33, v114
    v_add_f32 v34, v34, v114
    v_add_f32 v35, v35, v114
    v_add_f32 v36, v36, v114
    v_add_f32 v37, v37, v114
    v_add_f32 v38, v38, v114
    v_add_f32 v39, v39, v114
    s_waitcnt lgkmcnt(0)
    v_add_f32 v32, v32, v56
    v_add_f32 v80, v80, v104
    v_add_f32 v33, v33, v57
    v_add_f32 v81, v81, v105
    v_add_f32 v34, v34, v58
    v_add_f32 v82, v82, v106
    v_add_f32 v35, v35, v59
    v_add_f32 v83, v83, v107
    v_add_f32 v36, v36, v60
    v_add_f32 v84, v84, v108
    v_add_f32 v37, v37, v61
    v_add_f32 v85, v85, v109
    v_add_f32 v38, v38, v62
    v_add_f32 v86, v86, v110
    v_add_f32 v39, v39, v63
    v_add_f32 v87, v87, v111
    v_lshlrev_b32 v56, 16, v144
    v_and_b32 v57, 0xffff0000, v144
    v_lshlrev_b32 v58, 16, v145
    v_and_b32 v59, 0xffff0000, v145
    v_lshlrev_b32 v60, 16, v146
    v_and_b32 v61, 0xffff0000, v146
    v_lshlrev_b32 v62, 16, v147
    v_and_b32 v63, 0xffff0000, v147
    v_add_f32 v32, v32, v80
    v_add_f32 v33, v33, v81
    v_add_f32 v34, v34, v82
    v_add_f32 v35, v35, v83
    v_add_f32 v36, v36, v84
    v_add_f32 v37, v37, v85
    v_add_f32 v38, v38, v86
    v_add_f32 v39, v39, v87
    v_mul_f32 v32, v32, v56
    v_mul_f32 v33, v33, v57
    v_mul_f32 v34, v34, v58
    v_mul_f32 v35, v35, v59
    v_mul_f32 v36, v36, v60
    v_mul_f32 v37, v37, v61
    v_mul_f32 v38, v38, v62
    v_mul_f32 v39, v39, v63
    v_cvt_pk_bf16_f32 v32, v32, v33
    v_cvt_pk_bf16_f32 v33, v34, v35
    v_cvt_pk_bf16_f32 v34, v36, v37
    v_cvt_pk_bf16_f32 v35, v38, v39
    buffer_store_dwordx4 v[32:35], v8, s[16:19], s62 offen sc1
    s_branch MK_ERD
MK_ER1:
    ds_read_b128 v[16:19], v3 offset:6144
    ds_read_b128 v[20:23], v3 offset:7168
    ds_read_b128 v[64:67], v5 offset:6144
    ds_read_b128 v[68:71], v5 offset:7168
    ds_read_b128 v[88:91], v5 offset:30720
    ds_read_b128 v[92:95], v5 offset:31744
    ds_read_b128 v[24:27], v3 offset:8192
    ds_read_b128 v[28:31], v3 offset:9216
    ds_read_b128 v[72:75], v5 offset:8192
    ds_read_b128 v[76:79], v5 offset:9216
    ds_read_b128 v[96:99], v5 offset:32768
    ds_read_b128 v[100:103], v5 offset:33792
    s_waitcnt lgkmcnt(6)
    ds_read_b128 v[32:35], v3 offset:10240
    ds_read_b128 v[36:39], v3 offset:11264
    ds_read_b128 v[80:83], v5 offset:10240
    ds_read_b128 v[84:87], v5 offset:11264
    ds_read_b128 v[104:107], v5 offset:34816
    ds_read_b128 v[108:111], v5 offset:35840
    v_add_f32 v40, v40, v112
    v_add_f32 v41, v41, v112
    v_add_f32 v42, v42, v112
    v_add_f32 v43, v43, v112
    v_add_f32 v44, v44, v112
    v_add_f32 v45, v45, v112
    v_add_f32 v46, v46, v112
    v_add_f32 v47, v47, v112
    s_waitcnt lgkmcnt(12)
    v_add_f32 v40, v40, v16
    v_add_f32 v64, v64, v88
    v_add_f32 v41, v41, v17
    v_add_f32 v65, v65, v89
    v_add_f32 v42, v42, v18
    v_add_f32 v66, v66, v90
    v_add_f32 v43, v43, v19
    v_add_f32 v67, v67, v91
    v_add_f32 v44, v44, v20
    v_add_f32 v68, v68, v92
    v_add_f32 v45, v45, v21
    v_add_f32 v69, v69, v93
    v_add_f32 v46, v46, v22
    v_add_f32 v70, v70, v94
    v_add_f32 v47, v47, v23
    v_add_f32 v71, v71, v95
    v_lshlrev_b32 v16, 16, v136
    v_and_b32 v17, 0xffff0000, v136
    v_lshlrev_b32 v18, 16, v137
    v_and_b32 v19, 0xffff0000, v137
    v_lshlrev_b32 v20, 16, v138
    v_and_b32 v21, 0xffff0000, v138
    v_lshlrev_b32 v22, 16, v139
    v_and_b32 v23, 0xffff0000, v139
    v_add_f32 v40, v40, v64
    v_add_f32 v41, v41, v65
    v_add_f32 v42, v42, v66
    v_add_f32 v43, v43, v67
    v_add_f32 v44, v44, v68
    v_add_f32 v45, v45, v69
    v_add_f32 v46, v46, v70
    v_add_f32 v47, v47, v71
    v_mul_f32 v40, v40, v16
    v_mul_f32 v41, v41, v17
    v_mul_f32 v42, v42, v18
    v_mul_f32 v43, v43, v19
    v_mul_f32 v44, v44, v20
    v_mul_f32 v45, v45, v21
    v_mul_f32 v46, v46, v22
    v_mul_f32 v47, v47, v23
    v_cvt_pk_bf16_f32 v40, v40, v41
    v_cvt_pk_bf16_f32 v41, v42, v43
    v_cvt_pk_bf16_f32 v42, v44, v45
    v_cvt_pk_bf16_f32 v43, v46, v47
    buffer_store_dwordx4 v[40:43], v8, s[16:19], s60 offen sc1
    v_add_f32 v48, v48, v113
    v_add_f32 v49, v49, v113
    v_add_f32 v50, v50, v113
    v_add_f32 v51, v51, v113
    v_add_f32 v52, v52, v113
    v_add_f32 v53, v53, v113
    v_add_f32 v54, v54, v113
    v_add_f32 v55, v55, v113
    s_waitcnt lgkmcnt(6)
    v_add_f32 v48, v48, v24
    v_add_f32 v72, v72, v96
    v_add_f32 v49, v49, v25
    v_add_f32 v73, v73, v97
    v_add_f32 v50, v50, v26
    v_add_f32 v74, v74, v98
    v_add_f32 v51, v51, v27
    v_add_f32 v75, v75, v99
    v_add_f32 v52, v52, v28
    v_add_f32 v76, v76, v100
    v_add_f32 v53, v53, v29
    v_add_f32 v77, v77, v101
    v_add_f32 v54, v54, v30
    v_add_f32 v78, v78, v102
    v_add_f32 v55, v55, v31
    v_add_f32 v79, v79, v103
    v_lshlrev_b32 v24, 16, v140
    v_and_b32 v25, 0xffff0000, v140
    v_lshlrev_b32 v26, 16, v141
    v_and_b32 v27, 0xffff0000, v141
    v_lshlrev_b32 v28, 16, v142
    v_and_b32 v29, 0xffff0000, v142
    v_lshlrev_b32 v30, 16, v143
    v_and_b32 v31, 0xffff0000, v143
    v_add_f32 v48, v48, v72
    v_add_f32 v49, v49, v73
    v_add_f32 v50, v50, v74
    v_add_f32 v51, v51, v75
    v_add_f32 v52, v52, v76
    v_add_f32 v53, v53, v77
    v_add_f32 v54, v54, v78
    v_add_f32 v55, v55, v79
    v_mul_f32 v48, v48, v24
    v_mul_f32 v49, v49, v25
    v_mul_f32 v50, v50, v26
    v_mul_f32 v51, v51, v27
    v_mul_f32 v52, v52, v28
    v_mul_f32 v53, v53, v29
    v_mul_f32 v54, v54, v30
    v_mul_f32 v55, v55, v31
    v_cvt_pk_bf16_f32 v48, v48, v49
    v_cvt_pk_bf16_f32 v49, v50, v51
    v_cvt_pk_bf16_f32 v50, v52, v53
    v_cvt_pk_bf16_f32 v51, v54, v55
    buffer_store_dwordx4 v[48:51], v8, s[16:19], s61 offen sc1
    v_add_f32 v56, v56, v114
    v_add_f32 v57, v57, v114
    v_add_f32 v58, v58, v114
    v_add_f32 v59, v59, v114
    v_add_f32 v60, v60, v114
    v_add_f32 v61, v61, v114
    v_add_f32 v62, v62, v114
    v_add_f32 v63, v63, v114
    s_waitcnt lgkmcnt(0)
    v_add_f32 v56, v56, v32
    v_add_f32 v80, v80, v104
    v_add_f32 v57, v57, v33
    v_add_f32 v81, v81, v105
    v_add_f32 v58, v58, v34
    v_add_f32 v82, v82, v106
    v_add_f32 v59, v59, v35
    v_add_f32 v83, v83, v107
    v_add_f32 v60, v60, v36
    v_add_f32 v84, v84, v108
    v_add_f32 v61, v61, v37
    v_add_f32 v85, v85, v109
    v_add_f32 v62, v62, v38
    v_add_f32 v86, v86, v110
    v_add_f32 v63, v63, v39
    v_add_f32 v87, v87, v111
    v_lshlrev_b32 v32, 16, v144
    v_and_b32 v33, 0xffff0000, v144
    v_lshlrev_b32 v34, 16, v145
    v_and_b32 v35, 0xffff0000, v145
    v_lshlrev_b32 v36, 16, v146
    v_and_b32 v37, 0xffff0000, v146
    v_lshlrev_b32 v38, 16, v147
    v_and_b32 v39, 0xffff0000, v147
    v_add_f32 v56, v56, v80
    v_add_f32 v57, v57, v81
    v_add_f32 v58, v58, v82
    v_add_f32 v59, v59, v83
    v_add_f32 v60, v60, v84
    v_add_f32 v61, v61, v85
    v_add_f32 v62, v62, v86
    v_add_f32 v63, v63, v87
    v_mul_f32 v56, v56, v32
    v_mul_f32 v57, v57, v33
    v_mul_f32 v58, v58, v34
    v_mul_f32 v59, v59, v35
    v_mul_f32 v60, v60, v36
    v_mul_f32 v61, v61, v37
    v_mul_f32 v62, v62, v38
    v_mul_f32 v63, v63, v39
    v_cvt_pk_bf16_f32 v56, v56, v57
    v_cvt_pk_bf16_f32 v57, v58, v59
    v_cvt_pk_bf16_f32 v58, v60, v61
    v_cvt_pk_bf16_f32 v59, v62, v63
    buffer_store_dwordx4 v[56:59], v8, s[16:19], s62 offen sc1
    s_branch MK_ERD
MK_ER2:
    ds_read_b128 v[16:19], v3 offset:12288
    ds_read_b128 v[20:23], v3 offset:13312
    ds_read_b128 v[40:43], v3 offset:36864
    ds_read_b128 v[44:47], v3 offset:37888
    ds_read_b128 v[88:91], v5 offset:36864
    ds_read_b128 v[92:95], v5 offset:37888
    ds_read_b128 v[24:27], v3 offset:14336
    ds_read_b128 v[28:31], v3 offset:15360
    ds_read_b128 v[48:51], v3 offset:38912
    ds_read_b128 v[52:55], v3 offset:39936
    ds_read_b128 v[96:99], v5 offset:38912
    ds_read_b128 v[100:103], v5 offset:39936
    s_waitcnt lgkmcnt(6)
    ds_read_b128 v[32:35], v3 offset:16384
    ds_read_b128 v[36:39], v3 offset:17408
    ds_read_b128 v[56:59], v3 offset:40960
    ds_read_b128 v[60:63], v3 offset:41984
    ds_read_b128 v[104:107], v5 offset:40960
    ds_read_b128 v[108:111], v5 offset:41984
    v_add_f32 v64, v64, v112
    v_add_f32 v65, v65, v112
    v_add_f32 v66, v66, v112
    v_add_f32 v67, v67, v112
    v_add_f32 v68, v68, v112
    v_add_f32 v69, v69, v112
    v_add_f32 v70, v70, v112
    v_add_f32 v71, v71, v112
    s_waitcnt lgkmcnt(12)
    v_add_f32 v64, v64, v16
    v_add_f32 v40, v40, v88
    v_add_f32 v65, v65, v17
    v_add_f32 v41, v41, v89
    v_add_f32 v66, v66, v18
    v_add_f32 v42, v42, v90
    v_add_f32 v67, v67, v19
    v_add_f32 v43, v43, v91
    v_add_f32 v68, v68, v20
    v_add_f32 v44, v44, v92
    v_add_f32 v69, v69, v21
    v_add_f32 v45, v45, v93
    v_add_f32 v70, v70, v22
    v_add_f32 v46, v46, v94
    v_add_f32 v71, v71, v23
    v_add_f32 v47, v47, v95
    v_lshlrev_b32 v16, 16, v136
    v_and_b32 v17, 0xffff0000, v136
    v_lshlrev_b32 v18, 16, v137
    v_and_b32 v19, 0xffff0000, v137
    v_lshlrev_b32 v20, 16, v138
    v_and_b32 v21, 0xffff0000, v138
    v_lshlrev_b32 v22, 16, v139
    v_and_b32 v23, 0xffff0000, v139
    v_add_f32 v64, v64, v40
    v_add_f32 v65, v65, v41
    v_add_f32 v66, v66, v42
    v_add_f32 v67, v67, v43
    v_add_f32 v68, v68, v44
    v_add_f32 v69, v69, v45
    v_add_f32 v70, v70, v46
    v_add_f32 v71, v71, v47
    v_mul_f32 v64, v64, v16
    v_mul_f32 v65, v65, v17
    v_mul_f32 v66, v66, v18
    v_mul_f32 v67, v67, v19
    v_mul_f32 v68, v68, v20
    v_mul_f32 v69, v69, v21
    v_mul_f32 v70, v70, v22
    v_mul_f32 v71, v71, v23
    v_cvt_pk_bf16_f32 v64, v64, v65
    v_cvt_pk_bf16_f32 v65, v66, v67
    v_cvt_pk_bf16_f32 v66, v68, v69
    v_cvt_pk_bf16_f32 v67, v70, v71
    buffer_store_dwordx4 v[64:67], v8, s[16:19], s60 offen sc1
    v_add_f32 v72, v72, v113
    v_add_f32 v73, v73, v113
    v_add_f32 v74, v74, v113
    v_add_f32 v75, v75, v113
    v_add_f32 v76, v76, v113
    v_add_f32 v77, v77, v113
    v_add_f32 v78, v78, v113
    v_add_f32 v79, v79, v113
    s_waitcnt lgkmcnt(6)
    v_add_f32 v72, v72, v24
    v_add_f32 v48, v48, v96
    v_add_f32 v73, v73, v25
    v_add_f32 v49, v49, v97
    v_add_f32 v74, v74, v26
    v_add_f32 v50, v50, v98
    v_add_f32 v75, v75, v27
    v_add_f32 v51, v51, v99
    v_add_f32 v76, v76, v28
    v_add_f32 v52, v52, v100
    v_add_f32 v77, v77, v29
    v_add_f32 v53, v53, v101
    v_add_f32 v78, v78, v30
    v_add_f32 v54, v54, v102
    v_add_f32 v79, v79, v31
    v_add_f32 v55, v55, v103
    v_lshlrev_b32 v24, 16, v140
    v_and_b32 v25, 0xffff0000, v140
    v_lshlrev_b32 v26, 16, v141
    v_and_b32 v27, 0xffff0000, v141
    v_lshlrev_b32 v28, 16, v142
    v_and_b32 v29, 0xffff0000, v142
    v_lshlrev_b32 v30, 16, v143
    v_and_b32 v31, 0xffff0000, v143
    v_add_f32 v72, v72, v48
    v_add_f32 v73, v73, v49
    v_add_f32 v74, v74, v50
    v_add_f32 v75, v75, v51
    v_add_f32 v76, v76, v52
    v_add_f32 v77, v77, v53
    v_add_f32 v78, v78, v54
    v_add_f32 v79, v79, v55
    v_mul_f32 v72, v72, v24
    v_mul_f32 v73, v73, v25
    v_mul_f32 v74, v74, v26
    v_mul_f32 v75, v75, v27
    v_mul_f32 v76, v76, v28
    v_mul_f32 v77, v77, v29
    v_mul_f32 v78, v78, v30
    v_mul_f32 v79, v79, v31
    v_cvt_pk_bf16_f32 v72, v72, v73
    v_cvt_pk_bf16_f32 v73, v74, v75
    v_cvt_pk_bf16_f32 v74, v76, v77
    v_cvt_pk_bf16_f32 v75, v78, v79
    buffer_store_dwordx4 v[72:75], v8, s[16:19], s61 offen sc1
    v_add_f32 v80, v80, v114
    v_add_f32 v81, v81, v114
    v_add_f32 v82, v82, v114
    v_add_f32 v83, v83, v114
    v_add_f32 v84, v84, v114
    v_add_f32 v85, v85, v114
    v_add_f32 v86, v86, v114
    v_add_f32 v87, v87, v114
    s_waitcnt lgkmcnt(0)
    v_add_f32 v80, v80, v32
    v_add_f32 v56, v56, v104
    v_add_f32 v81, v81, v33
    v_add_f32 v57, v57, v105
    v_add_f32 v82, v82, v34
    v_add_f32 v58, v58, v106
    v_add_f32 v83, v83, v35
    v_add_f32 v59, v59, v107
    v_add_f32 v84, v84, v36
    v_add_f32 v60, v60, v108
    v_add_f32 v85, v85, v37
    v_add_f32 v61, v61, v109
    v_add_f32 v86, v86, v38
    v_add_f32 v62, v62, v110
    v_add_f32 v87, v87, v39
    v_add_f32 v63, v63, v111
    v_lshlrev_b32 v32, 16, v144
    v_and_b32 v33, 0xffff0000, v144
    v_lshlrev_b32 v34, 16, v145
    v_and_b32 v35, 0xffff0000, v145
    v_lshlrev_b32 v36, 16, v146
    v_and_b32 v37, 0xffff0000, v146
    v_lshlrev_b32 v38, 16, v147
    v_and_b32 v39, 0xffff0000, v147
    v_add_f32 v80, v80, v56
    v_add_f32 v81, v81, v57
    v_add_f32 v82, v82, v58
    v_add_f32 v83, v83, v59
    v_add_f32 v84, v84, v60
    v_add_f32 v85, v85, v61
    v_add_f32 v86, v86, v62
    v_add_f32 v87, v87, v63
    v_mul_f32 v80, v80, v32
    v_mul_f32 v81, v81, v33
    v_mul_f32 v82, v82, v34
    v_mul_f32 v83, v83, v35
    v_mul_f32 v84, v84, v36
    v_mul_f32 v85, v85, v37
    v_mul_f32 v86, v86, v38
    v_mul_f32 v87, v87, v39
    v_cvt_pk_bf16_f32 v80, v80, v81
    v_cvt_pk_bf16_f32 v81, v82, v83
    v_cvt_pk_bf16_f32 v82, v84, v85
    v_cvt_pk_bf16_f32 v83, v86, v87
    buffer_store_dwordx4 v[80:83], v8, s[16:19], s62 offen sc1
    s_branch MK_ERD
MK_ER3:
    ds_read_b128 v[16:19], v3 offset:18432
    ds_read_b128 v[20:23], v3 offset:19456
    ds_read_b128 v[40:43], v3 offset:43008
    ds_read_b128 v[44:47], v3 offset:44032
    ds_read_b128 v[64:67], v5 offset:18432
    ds_read_b128 v[68:71], v5 offset:19456
    ds_read_b128 v[24:27], v3 offset:20480
    ds_read_b128 v[28:31], v3 offset:21504
    ds_read_b128 v[48:51], v3 offset:45056
    ds_read_b128 v[52:55], v3 offset:46080
    ds_read_b128 v[72:75], v5 offset:20480
    ds_read_b128 v[76:79], v5 offset:21504
    s_waitcnt lgkmcnt(6)
    ds_read_b128 v[32:35], v3 offset:22528
    ds_read_b128 v[36:39], v3 offset:23552
    ds_read_b128 v[56:59], v3 offset:47104
    ds_read_b128 v[60:63], v3 offset:48128
    ds_read_b128 v[80:83], v5 offset:22528
    ds_read_b128 v[84:87], v5 offset:23552
    v_add_f32 v88, v88, v112
    v_add_f32 v89, v89, v112
    v_add_f32 v90, v90, v112
    v_add_f32 v91, v91, v112
    v_add_f32 v92, v92, v112
    v_add_f32 v93, v93, v112
    v_add_f32 v94, v94, v112
    v_add_f32 v95, v95, v112
    s_waitcnt lgkmcnt(12)
    v_add_f32 v88, v88, v16
    v_add_f32 v40, v40, v64
    v_add_f32 v89, v89, v17
    v_add_f32 v41, v41, v65
    v_add_f32 v90, v90, v18
    v_add_f32 v42, v42, v66
    v_add_f32 v91, v91, v19
    v_add_f32 v43, v43, v67
    v_add_f32 v92, v92, v20
    v_add_f32 v44, v44, v68
    v_add_f32 v93, v93, v21
    v_add_f32 v45, v45, v69
    v_add_f32 v94, v94, v22
    v_add_f32 v46, v46, v70
    v_add_f32 v95, v95, v23
    v_add_f32 v47, v47, v71
    v_lshlrev_b32 v16, 16, v136
    v_and_b32 v17, 0xffff0000, v136
    v_lshlrev_b32 v18, 16, v137
    v_and_b32 v19, 0xffff0000, v137
    v_lshlrev_b32 v20, 16, v138
    v_and_b32 v21, 0xffff0000, v138
    v_lshlrev_b32 v22, 16, v139
    v_and_b32 v23, 0xffff0000, v139
    v_add_f32 v88, v88, v40
    v_add_f32 v89, v89, v41
    v_add_f32 v90, v90, v42
    v_add_f32 v91, v91, v43
    v_add_f32 v92, v92, v44
    v_add_f32 v93, v93, v45
    v_add_f32 v94, v94, v46
    v_add_f32 v95, v95, v47
    v_mul_f32 v88, v88, v16
    v_mul_f32 v89, v89, v17
    v_mul_f32 v90, v90, v18
    v_mul_f32 v91, v91, v19
    v_mul_f32 v92, v92, v20
    v_mul_f32 v93, v93, v21
    v_mul_f32 v94, v94, v22
    v_mul_f32 v95, v95, v23
    v_cvt_pk_bf16_f32 v88, v88, v89
    v_cvt_pk_bf16_f32 v89, v90, v91
    v_cvt_pk_bf16_f32 v90, v92, v93
    v_cvt_pk_bf16_f32 v91, v94, v95
    buffer_store_dwordx4 v[88:91], v8, s[16:19], s60 offen sc1
    v_add_f32 v96, v96, v113
    v_add_f32 v97, v97, v113
    v_add_f32 v98, v98, v113
    v_add_f32 v99, v99, v113
    v_add_f32 v100, v100, v113
    v_add_f32 v101, v101, v113
    v_add_f32 v102, v102, v113
    v_add_f32 v103, v103, v113
    s_waitcnt lgkmcnt(6)
    v_add_f32 v96, v96, v24
    v_add_f32 v48, v48, v72
    v_add_f32 v97, v97, v25
    v_add_f32 v49, v49, v73
    v_add_f32 v98, v98, v26
    v_add_f32 v50, v50, v74
    v_add_f32 v99, v99, v27
    v_add_f32 v51, v51, v75
    v_add_f32 v100, v100, v28
    v_add_f32 v52, v52, v76
    v_add_f32 v101, v101, v29
    v_add_f32 v53, v53, v77
    v_add_f32 v102, v102, v30
    v_add_f32 v54, v54, v78
    v_add_f32 v103, v103, v31
    v_add_f32 v55, v55, v79
    v_lshlrev_b32 v24, 16, v140
    v_and_b32 v25, 0xffff0000, v140
    v_lshlrev_b32 v26, 16, v141
    v_and_b32 v27, 0xffff0000, v141
    v_lshlrev_b32 v28, 16, v142
    v_and_b32 v29, 0xffff0000, v142
    v_lshlrev_b32 v30, 16, v143
    v_and_b32 v31, 0xffff0000, v143
    v_add_f32 v96, v96, v48
    v_add_f32 v97, v97, v49
    v_add_f32 v98, v98, v50
    v_add_f32 v99, v99, v51
    v_add_f32 v100, v100, v52
    v_add_f32 v101, v101, v53
    v_add_f32 v102, v102, v54
    v_add_f32 v103, v103, v55
    v_mul_f32 v96, v96, v24
    v_mul_f32 v97, v97, v25
    v_mul_f32 v98, v98, v26
    v_mul_f32 v99, v99, v27
    v_mul_f32 v100, v100, v28
    v_mul_f32 v101, v101, v29
    v_mul_f32 v102, v102, v30
    v_mul_f32 v103, v103, v31
    v_cvt_pk_bf16_f32 v96, v96, v97
    v_cvt_pk_bf16_f32 v97, v98, v99
    v_cvt_pk_bf16_f32 v98, v100, v101
    v_cvt_pk_bf16_f32 v99, v102, v103
    buffer_store_dwordx4 v[96:99], v8, s[16:19], s61 offen sc1
    v_add_f32 v104, v104, v114
    v_add_f32 v105, v105, v114
    v_add_f32 v106, v106, v114
    v_add_f32 v107, v107, v114
    v_add_f32 v108, v108, v114
    v_add_f32 v109, v109, v114
    v_add_f32 v110, v110, v114
    v_add_f32 v111, v111, v114
    s_waitcnt lgkmcnt(0)
    v_add_f32 v104, v104, v32
    v_add_f32 v56, v56, v80
    v_add_f32 v105, v105, v33
    v_add_f32 v57, v57, v81
    v_add_f32 v106, v106, v34
    v_add_f32 v58, v58, v82
    v_add_f32 v107, v107, v35
    v_add_f32 v59, v59, v83
    v_add_f32 v108, v108, v36
    v_add_f32 v60, v60, v84
    v_add_f32 v109, v109, v37
    v_add_f32 v61, v61, v85
    v_add_f32 v110, v110, v38
    v_add_f32 v62, v62, v86
    v_add_f32 v111, v111, v39
    v_add_f32 v63, v63, v87
    v_lshlrev_b32 v32, 16, v144
    v_and_b32 v33, 0xffff0000, v144
    v_lshlrev_b32 v34, 16, v145
    v_and_b32 v35, 0xffff0000, v145
    v_lshlrev_b32 v36, 16, v146
    v_and_b32 v37, 0xffff0000, v146
    v_lshlrev_b32 v38, 16, v147
    v_and_b32 v39, 0xffff0000, v147
    v_add_f32 v104, v104, v56
    v_add_f32 v105, v105, v57
    v_add_f32 v106, v106, v58
    v_add_f32 v107, v107, v59
    v_add_f32 v108, v108, v60
    v_add_f32 v109, v109, v61
    v_add_f32 v110, v110, v62
    v_add_f32 v111, v111, v63
    v_mul_f32 v104, v104, v32
    v_mul_f32 v105, v105, v33
    v_mul_f32 v106, v106, v34
    v_mul_f32 v107, v107, v35
    v_mul_f32 v108, v108, v36
    v_mul_f32 v109, v109, v37
    v_mul_f32 v110, v110, v38
    v_mul_f32 v111, v111, v39
    v_cvt_pk_bf16_f32 v104, v104, v105
    v_cvt_pk_bf16_f32 v105, v106, v107
    v_cvt_pk_bf16_f32 v106, v108, v109
    v_cvt_pk_bf16_f32 v107, v110, v111
    buffer_store_dwordx4 v[104:107], v8, s[16:19], s62 offen sc1
MK_ERD:
    s_setprio 3

    s_mul_i32 s41, s39, 225280
    s_mul_i32 s42, s40, 30720
    s_add_u32 s41, s41, s42
    s_add_u32 s41, s41, 0x1600000
    s_mul_i32 s42, s40, 24576
    v_add_u32 v4, s42, v3
    s_mul_i32 s43, s38, 180224
    s_mul_i32 s47, s40, 6144
    s_add_u32 s43, s43, s47
    s_add_u32 s43, s43, 0x1080000
    s_lshl_b32 s55, s34, 10
    s_and_b32 s50, s35, 3
    s_lshl_b32 s50, s50, 8
    s_add_u32 s55, s55, s50
    s_add_u32 s55, s55, 0x1846000
    s_lshl_b32 s54, s39, 2
    s_add_u32 s54, s54, s55
    s_waitcnt vmcnt(0)
    s_mov_b64 exec, 1
    v_mov_b32 v164, 162980
    v_mov_b32 v165, 1
    ds_add_rtn_u32 v165, v164, v165
    s_waitcnt lgkmcnt(0)
    v_readfirstlane_b32 s50, v165
    s_nop 0
    s_cmp_lg_u32 s50, 3
    s_cbranch_scc1 MK_S5_SENT
    s_mov_b64 exec, 1
    v_mov_b32 v164, s86
    v_mov_b32 v165, 0
    buffer_store_dword v164, v165, s[16:19], s54 offen sc1
    s_mov_b64 exec, -1
MK_S5_SENT:
    s_mov_b64 exec, -1

    v_mov_b32 v165, 162980
MK_E2:
    ds_read_b32 v164, v165
    s_waitcnt lgkmcnt(0)
    v_cmp_gt_u32 vcc, 4, v164
    s_cbranch_vccz MK_E2_OK
    s_sleep 1
    s_branch MK_E2
MK_E2_OK:
    s_add_u32 m0, s42, 0
    s_add_u32 s50, s41, 102400
    s_add_u32 s51, s41, 106496
    buffer_load_dwordx4 v3, s[16:19], s50 offen offset:0 sc1 lds
    buffer_load_dwordx4 v3, s[16:19], s50 offen offset:1024 sc1 lds
    buffer_load_dwordx4 v3, s[16:19], s50 offen offset:2048 sc1 lds
    buffer_load_dwordx4 v3, s[16:19], s50 offen offset:3072 sc1 lds
    s_add_u32 m0, s42, 4096
    s_nop 0
    buffer_load_dwordx4 v3, s[16:19], s51 offen sc1 lds
    s_add_u32 m0, s42, 5120
    s_add_u32 s50, s41, 107520
    s_add_u32 s51, s41, 111616
    buffer_load_dwordx4 v3, s[16:19], s50 offen offset:0 sc1 lds
    buffer_load_dwordx4 v3, s[16:19], s50 offen offset:1024 sc1 lds
    buffer_load_dwordx4 v3, s[16:19], s50 offen offset:2048 sc1 lds
    buffer_load_dwordx4 v3, s[16:19], s50 offen offset:3072 sc1 lds
    s_add_u32 m0, s42, 9216
    s_nop 0
    buffer_load_dwordx4 v3, s[16:19], s51 offen sc1 lds
    s_add_u32 m0, s42, 10240
    s_add_u32 s50, s41, 112640
    s_add_u32 s51, s41, 116736
    buffer_load_dwordx4 v3, s[16:19], s50 offen offset:0 sc1 lds
    buffer_load_dwordx4 v3, s[16:19], s50 offen offset:1024 sc1 lds
    buffer_load_dwordx4 v3, s[16:19], s50 offen offset:2048 sc1 lds
    buffer_load_dwordx4 v3, s[16:19], s50 offen offset:3072 sc1 lds
    s_add_u32 m0, s42, 14336
    s_nop 0
    buffer_load_dwordx4 v3, s[16:19], s51 offen sc1 lds
    s_add_u32 m0, s42, 15360
    s_add_u32 s50, s41, 117760
    s_add_u32 s51, s41, 121856
    buffer_load_dwordx4 v3, s[16:19], s50 offen offset:0 sc1 lds
    buffer_load_dwordx4 v3, s[16:19], s50 offen offset:1024 sc1 lds
    buffer_load_dwordx4 v3, s[16:19], s50 offen offset:2048 sc1 lds
    buffer_load_dwordx4 v3, s[16:19], s50 offen offset:3072 sc1 lds
    s_add_u32 m0, s42, 19456
    s_nop 0
    buffer_load_dwordx4 v3, s[16:19], s51 offen sc1 lds
    s_lshl_b32 s50, s40, 3
    s_add_u32 s55, s55, s50
    s_add_u32 s57, s55, 4
    v_mov_b32 v164, 0
    s_mov_b32 s56, 0
MK_S5P:
    buffer_load_dword v165, v164, s[16:19], s55 offen sc1
    s_waitcnt vmcnt(0)
    v_cmp_ne_u32 vcc, s86, v165
    s_cbranch_vccz MK_S5P_OK
    s_add_u32 s56, s56, 1
    s_cmp_gt_u32 s56, 200000
    s_cbranch_scc1 MK_S5P_OK
    s_sleep 3
    s_branch MK_S5P
MK_S5P_OK:

    s_add_u32 s50, s43, 20480
    buffer_load_dwordx4 v[96:99], v3, s[16:19], s50 offen sc1
    s_add_u32 s50, s43, 65536
    buffer_load_dwordx4 v[100:103], v3, s[16:19], s50 offen sc1
    s_add_u32 s50, s43, 110592
    buffer_load_dwordx4 v[104:107], v3, s[16:19], s50 offen sc1
    s_add_u32 s50, s43, 155648
    buffer_load_dwordx4 v[108:111], v3, s[16:19], s50 offen sc1
    s_add_u32 s50, s43, 21504
    buffer_load_dwordx4 v[112:115], v3, s[16:19], s50 offen sc1
    s_add_u32 s50, s43, 66560
    buffer_load_dwordx4 v[116:119], v3, s[16:19], s50 offen sc1
    s_add_u32 s50, s43, 111616
    buffer_load_dwordx4 v[120:123], v3, s[16:19], s50 offen sc1
    s_add_u32 s50, s43, 156672
    buffer_load_dwordx4 v[124:127], v3, s[16:19], s50 offen sc1
    s_add_u32 s50, s43, 22528
    buffer_load_dwordx4 v[128:131], v3, s[16:19], s50 offen sc1
    s_add_u32 s50, s43, 67584
    buffer_load_dwordx4 v[132:135], v3, s[16:19], s50 offen sc1
    s_add_u32 s50, s43, 112640
    buffer_load_dwordx4 v[136:139], v3, s[16:19], s50 offen sc1
    s_add_u32 s50, s43, 157696
    buffer_load_dwordx4 v[140:143], v3, s[16:19], s50 offen sc1
    v_and_b32 v165, 7, v2
    v_lshlrev_b32 v165, 2, v165
    v_add_u32 v165, 162912, v165
MK_PGL:
    ds_read_b32 v164, v165
    s_waitcnt lgkmcnt(0)
    v_cmp_gt_u32 vcc, 8, v164
    s_cbranch_vccz MK_PGLD
    s_sleep 4
    s_branch MK_PGL
MK_PGLD:
    v_mov_b32 v164, 0
    buffer_load_dword v165, v164, s[16:19], s57 offen sc1
    s_setprio 3
    ds_read_b128 v[144:147], v4 offset:0
    ds_read_b128 v[148:151], v4 offset:1024
    ds_read_b128 v[152:155], v4 offset:2048
    ds_read_b128 v[156:159], v4 offset:3072
    ds_read_b128 v[160:163], v4 offset:4096
    s_waitcnt vmcnt(9)
    s_waitcnt lgkmcnt(4)
    v_mfma_f32_16x16x32_bf16 v[16:19], v[144:147], v[96:99], 0
    v_mfma_f32_16x16x32_bf16 v[20:23], v[144:147], v[100:103], 0
    v_mfma_f32_16x16x32_bf16 v[24:27], v[144:147], v[104:107], 0
    v_mfma_f32_16x16x32_bf16 v[28:31], v[144:147], v[108:111], 0
    s_waitcnt lgkmcnt(3)
    v_mfma_f32_16x16x32_bf16 v[32:35], v[148:151], v[96:99], 0
    v_mfma_f32_16x16x32_bf16 v[36:39], v[148:151], v[100:103], 0
    v_mfma_f32_16x16x32_bf16 v[40:43], v[148:151], v[104:107], 0
    v_mfma_f32_16x16x32_bf16 v[44:47], v[148:151], v[108:111], 0
    s_waitcnt lgkmcnt(2)
    v_mfma_f32_16x16x32_bf16 v[48:51], v[152:155], v[96:99], 0
    v_mfma_f32_16x16x32_bf16 v[52:55], v[152:155], v[100:103], 0
    v_mfma_f32_16x16x32_bf16 v[56:59], v[152:155], v[104:107], 0
    v_mfma_f32_16x16x32_bf16 v[60:63], v[152:155], v[108:111], 0
    s_waitcnt lgkmcnt(1)
    v_mfma_f32_16x16x32_bf16 v[64:67], v[156:159], v[96:99], 0
    v_mfma_f32_16x16x32_bf16 v[68:71], v[156:159], v[100:103], 0
    v_mfma_f32_16x16x32_bf16 v[72:75], v[156:159], v[104:107], 0
    v_mfma_f32_16x16x32_bf16 v[76:79], v[156:159], v[108:111], 0
    s_waitcnt lgkmcnt(0)
    v_mfma_f32_16x16x32_bf16 v[80:83], v[160:163], v[96:99], 0
    v_mfma_f32_16x16x32_bf16 v[84:87], v[160:163], v[100:103], 0
    v_mfma_f32_16x16x32_bf16 v[88:91], v[160:163], v[104:107], 0
    v_mfma_f32_16x16x32_bf16 v[92:95], v[160:163], v[108:111], 0
    s_add_u32 m0, s42, 0
    s_add_u32 s50, s41, 122880
    s_add_u32 s51, s41, 126976
    buffer_load_dwordx4 v3, s[16:19], s50 offen offset:0 sc1 lds
    buffer_load_dwordx4 v3, s[16:19], s50 offen offset:1024 sc1 lds
    buffer_load_dwordx4 v3, s[16:19], s50 offen offset:2048 sc1 lds
    buffer_load_dwordx4 v3, s[16:19], s50 offen offset:3072 sc1 lds
    s_add_u32 m0, s42, 4096
    s_nop 0
    buffer_load_dwordx4 v3, s[16:19], s51 offen sc1 lds
    ds_read_b128 v[144:147], v4 offset:5120
    ds_read_b128 v[148:151], v4 offset:6144
    ds_read_b128 v[152:155], v4 offset:7168
    ds_read_b128 v[156:159], v4 offset:8192
    ds_read_b128 v[160:163], v4 offset:9216
    s_waitcnt vmcnt(10)
    s_waitcnt lgkmcnt(4)
    v_mfma_f32_16x16x32_bf16 v[16:19], v[144:147], v[112:115], v[16:19]
    v_mfma_f32_16x16x32_bf16 v[20:23], v[144:147], v[116:119], v[20:23]
    v_mfma_f32_16x16x32_bf16 v[24:27], v[144:147], v[120:123], v[24:27]
    v_mfma_f32_16x16x32_bf16 v[28:31], v[144:147], v[124:127], v[28:31]
    s_waitcnt lgkmcnt(3)
    v_mfma_f32_16x16x32_bf16 v[32:35], v[148:151], v[112:115], v[32:35]
    v_mfma_f32_16x16x32_bf16 v[36:39], v[148:151], v[116:119], v[36:39]
    v_mfma_f32_16x16x32_bf16 v[40:43], v[148:151], v[120:123], v[40:43]
    v_mfma_f32_16x16x32_bf16 v[44:47], v[148:151], v[124:127], v[44:47]
    s_waitcnt lgkmcnt(2)
    v_mfma_f32_16x16x32_bf16 v[48:51], v[152:155], v[112:115], v[48:51]
    v_mfma_f32_16x16x32_bf16 v[52:55], v[152:155], v[116:119], v[52:55]
    v_mfma_f32_16x16x32_bf16 v[56:59], v[152:155], v[120:123], v[56:59]
    v_mfma_f32_16x16x32_bf16 v[60:63], v[152:155], v[124:127], v[60:63]
    s_waitcnt lgkmcnt(1)
    v_mfma_f32_16x16x32_bf16 v[64:67], v[156:159], v[112:115], v[64:67]
    v_mfma_f32_16x16x32_bf16 v[68:71], v[156:159], v[116:119], v[68:71]
    v_mfma_f32_16x16x32_bf16 v[72:75], v[156:159], v[120:123], v[72:75]
    v_mfma_f32_16x16x32_bf16 v[76:79], v[156:159], v[124:127], v[76:79]
    s_waitcnt lgkmcnt(0)
    v_mfma_f32_16x16x32_bf16 v[80:83], v[160:163], v[112:115], v[80:83]
    v_mfma_f32_16x16x32_bf16 v[84:87], v[160:163], v[116:119], v[84:87]
    v_mfma_f32_16x16x32_bf16 v[88:91], v[160:163], v[120:123], v[88:91]
    v_mfma_f32_16x16x32_bf16 v[92:95], v[160:163], v[124:127], v[92:95]
    s_add_u32 m0, s42, 5120
    s_add_u32 s50, s41, 128000
    s_add_u32 s51, s41, 132096
    buffer_load_dwordx4 v3, s[16:19], s50 offen offset:0 sc1 lds
    buffer_load_dwordx4 v3, s[16:19], s50 offen offset:1024 sc1 lds
    buffer_load_dwordx4 v3, s[16:19], s50 offen offset:2048 sc1 lds
    buffer_load_dwordx4 v3, s[16:19], s50 offen offset:3072 sc1 lds
    s_add_u32 m0, s42, 9216
    s_nop 0
    buffer_load_dwordx4 v3, s[16:19], s51 offen sc1 lds
    s_waitcnt vmcnt(10)
    s_setprio 3
    v_cmp_ne_u32 vcc, s86, v165
    s_cbranch_vccz MK_S5Q_OK
    s_mov_b32 s56, 0
MK_S5Q:
    buffer_load_dword v165, v164, s[16:19], s57 offen sc1
    s_waitcnt vmcnt(0)
    v_cmp_ne_u32 vcc, s86, v165
    s_cbranch_vccz MK_S5Q_OK
    s_add_u32 s56, s56, 1
    s_cmp_gt_u32 s56, 200000
    s_cbranch_scc1 MK_S5Q_OK
    s_sleep 3
    s_branch MK_S5Q
MK_S5Q_OK:
    s_setprio 3
    s_add_u32 s50, s43, 23552
    buffer_load_dwordx4 v[96:99], v3, s[16:19], s50 offen sc1
    s_add_u32 s50, s43, 68608
    buffer_load_dwordx4 v[100:103], v3, s[16:19], s50 offen sc1
    s_add_u32 s50, s43, 113664
    buffer_load_dwordx4 v[104:107], v3, s[16:19], s50 offen sc1
    s_add_u32 s50, s43, 158720
    buffer_load_dwordx4 v[108:111], v3, s[16:19], s50 offen sc1
    s_add_u32 s50, s43, 24576
    buffer_load_dwordx4 v[112:115], v3, s[16:19], s50 offen sc1
    s_add_u32 s50, s43, 69632
    buffer_load_dwordx4 v[116:119], v3, s[16:19], s50 offen sc1
    s_add_u32 s50, s43, 114688
    buffer_load_dwordx4 v[120:123], v3, s[16:19], s50 offen sc1
    s_add_u32 s50, s43, 159744
    buffer_load_dwordx4 v[124:127], v3, s[16:19], s50 offen sc1
    ds_read_b128 v[144:147], v4 offset:10240
    ds_read_b128 v[148:151], v4 offset:11264
    ds_read_b128 v[152:155], v4 offset:12288
    ds_read_b128 v[156:159], v4 offset:13312
    ds_read_b128 v[160:163], v4 offset:14336
    s_waitcnt lgkmcnt(4)
    v_mfma_f32_16x16x32_bf16 v[16:19], v[144:147], v[128:131], v[16:19]
    v_mfma_f32_16x16x32_bf16 v[20:23], v[144:147], v[132:135], v[20:23]
    v_mfma_f32_16x16x32_bf16 v[24:27], v[144:147], v[136:139], v[24:27]
    v_mfma_f32_16x16x32_bf16 v[28:31], v[144:147], v[140:143], v[28:31]
    s_waitcnt lgkmcnt(3)
    v_mfma_f32_16x16x32_bf16 v[32:35], v[148:151], v[128:131], v[32:35]
    v_mfma_f32_16x16x32_bf16 v[36:39], v[148:151], v[132:135], v[36:39]
    v_mfma_f32_16x16x32_bf16 v[40:43], v[148:151], v[136:139], v[40:43]
    v_mfma_f32_16x16x32_bf16 v[44:47], v[148:151], v[140:143], v[44:47]
    s_waitcnt lgkmcnt(2)
    v_mfma_f32_16x16x32_bf16 v[48:51], v[152:155], v[128:131], v[48:51]
    v_mfma_f32_16x16x32_bf16 v[52:55], v[152:155], v[132:135], v[52:55]
    v_mfma_f32_16x16x32_bf16 v[56:59], v[152:155], v[136:139], v[56:59]
    v_mfma_f32_16x16x32_bf16 v[60:63], v[152:155], v[140:143], v[60:63]
    s_waitcnt lgkmcnt(1)
    v_mfma_f32_16x16x32_bf16 v[64:67], v[156:159], v[128:131], v[64:67]
    v_mfma_f32_16x16x32_bf16 v[68:71], v[156:159], v[132:135], v[68:71]
    v_mfma_f32_16x16x32_bf16 v[72:75], v[156:159], v[136:139], v[72:75]
    v_mfma_f32_16x16x32_bf16 v[76:79], v[156:159], v[140:143], v[76:79]
    s_waitcnt lgkmcnt(0)
    v_mfma_f32_16x16x32_bf16 v[80:83], v[160:163], v[128:131], v[80:83]
    v_mfma_f32_16x16x32_bf16 v[84:87], v[160:163], v[132:135], v[84:87]
    v_mfma_f32_16x16x32_bf16 v[88:91], v[160:163], v[136:139], v[88:91]
    v_mfma_f32_16x16x32_bf16 v[92:95], v[160:163], v[140:143], v[92:95]
    s_add_u32 s50, s43, 25600
    buffer_load_dwordx4 v[128:131], v3, s[16:19], s50 offen sc1
    s_add_u32 s50, s43, 70656
    buffer_load_dwordx4 v[132:135], v3, s[16:19], s50 offen sc1
    s_add_u32 s50, s43, 115712
    buffer_load_dwordx4 v[136:139], v3, s[16:19], s50 offen sc1
    s_add_u32 s50, s43, 160768
    buffer_load_dwordx4 v[140:143], v3, s[16:19], s50 offen sc1
    ds_read_b128 v[144:147], v4 offset:15360
    ds_read_b128 v[148:151], v4 offset:16384
    ds_read_b128 v[152:155], v4 offset:17408
    ds_read_b128 v[156:159], v4 offset:18432
    ds_read_b128 v[160:163], v4 offset:19456
    s_waitcnt vmcnt(8)
    s_waitcnt lgkmcnt(4)
    v_mfma_f32_16x16x32_bf16 v[16:19], v[144:147], v[96:99], v[16:19]
    v_mfma_f32_16x16x32_bf16 v[20:23], v[144:147], v[100:103], v[20:23]
    v_mfma_f32_16x16x32_bf16 v[24:27], v[144:147], v[104:107], v[24:27]
    v_mfma_f32_16x16x32_bf16 v[28:31], v[144:147], v[108:111], v[28:31]
    s_waitcnt lgkmcnt(3)
    v_mfma_f32_16x16x32_bf16 v[32:35], v[148:151], v[96:99], v[32:35]
    v_mfma_f32_16x16x32_bf16 v[36:39], v[148:151], v[100:103], v[36:39]
    v_mfma_f32_16x16x32_bf16 v[40:43], v[148:151], v[104:107], v[40:43]
    v_mfma_f32_16x16x32_bf16 v[44:47], v[148:151], v[108:111], v[44:47]
    s_waitcnt lgkmcnt(2)
    v_mfma_f32_16x16x32_bf16 v[48:51], v[152:155], v[96:99], v[48:51]
    v_mfma_f32_16x16x32_bf16 v[52:55], v[152:155], v[100:103], v[52:55]
    v_mfma_f32_16x16x32_bf16 v[56:59], v[152:155], v[104:107], v[56:59]
    v_mfma_f32_16x16x32_bf16 v[60:63], v[152:155], v[108:111], v[60:63]
    s_waitcnt lgkmcnt(1)
    v_mfma_f32_16x16x32_bf16 v[64:67], v[156:159], v[96:99], v[64:67]
    v_mfma_f32_16x16x32_bf16 v[68:71], v[156:159], v[100:103], v[68:71]
    v_mfma_f32_16x16x32_bf16 v[72:75], v[156:159], v[104:107], v[72:75]
    v_mfma_f32_16x16x32_bf16 v[76:79], v[156:159], v[108:111], v[76:79]
    s_waitcnt lgkmcnt(0)
    v_mfma_f32_16x16x32_bf16 v[80:83], v[160:163], v[96:99], v[80:83]
    v_mfma_f32_16x16x32_bf16 v[84:87], v[160:163], v[100:103], v[84:87]
    v_mfma_f32_16x16x32_bf16 v[88:91], v[160:163], v[104:107], v[88:91]
    v_mfma_f32_16x16x32_bf16 v[92:95], v[160:163], v[108:111], v[92:95]
    ds_read_b128 v[144:147], v4 offset:0
    ds_read_b128 v[148:151], v4 offset:1024
    ds_read_b128 v[152:155], v4 offset:2048
    ds_read_b128 v[156:159], v4 offset:3072
    ds_read_b128 v[160:163], v4 offset:4096
    s_waitcnt vmcnt(4)
    s_waitcnt lgkmcnt(4)
    v_mfma_f32_16x16x32_bf16 v[16:19], v[144:147], v[112:115], v[16:19]
    v_mfma_f32_16x16x32_bf16 v[20:23], v[144:147], v[116:119], v[20:23]
    v_mfma_f32_16x16x32_bf16 v[24:27], v[144:147], v[120:123], v[24:27]
    v_mfma_f32_16x16x32_bf16 v[28:31], v[144:147], v[124:127], v[28:31]
    s_waitcnt lgkmcnt(3)
    v_mfma_f32_16x16x32_bf16 v[32:35], v[148:151], v[112:115], v[32:35]
    v_mfma_f32_16x16x32_bf16 v[36:39], v[148:151], v[116:119], v[36:39]
    v_mfma_f32_16x16x32_bf16 v[40:43], v[148:151], v[120:123], v[40:43]
    v_mfma_f32_16x16x32_bf16 v[44:47], v[148:151], v[124:127], v[44:47]
    s_waitcnt lgkmcnt(2)
    v_mfma_f32_16x16x32_bf16 v[48:51], v[152:155], v[112:115], v[48:51]
    v_mfma_f32_16x16x32_bf16 v[52:55], v[152:155], v[116:119], v[52:55]
    v_mfma_f32_16x16x32_bf16 v[56:59], v[152:155], v[120:123], v[56:59]
    v_mfma_f32_16x16x32_bf16 v[60:63], v[152:155], v[124:127], v[60:63]
    s_waitcnt lgkmcnt(1)
    v_mfma_f32_16x16x32_bf16 v[64:67], v[156:159], v[112:115], v[64:67]
    v_mfma_f32_16x16x32_bf16 v[68:71], v[156:159], v[116:119], v[68:71]
    v_mfma_f32_16x16x32_bf16 v[72:75], v[156:159], v[120:123], v[72:75]
    v_mfma_f32_16x16x32_bf16 v[76:79], v[156:159], v[124:127], v[76:79]
    s_waitcnt lgkmcnt(0)
    v_mfma_f32_16x16x32_bf16 v[80:83], v[160:163], v[112:115], v[80:83]
    v_mfma_f32_16x16x32_bf16 v[84:87], v[160:163], v[116:119], v[84:87]
    v_mfma_f32_16x16x32_bf16 v[88:91], v[160:163], v[120:123], v[88:91]
    v_mfma_f32_16x16x32_bf16 v[92:95], v[160:163], v[124:127], v[92:95]
    ds_read_b128 v[144:147], v4 offset:5120
    ds_read_b128 v[148:151], v4 offset:6144
    ds_read_b128 v[152:155], v4 offset:7168
    ds_read_b128 v[156:159], v4 offset:8192
    ds_read_b128 v[160:163], v4 offset:9216
    s_waitcnt vmcnt(0)
    s_waitcnt lgkmcnt(4)
    v_mfma_f32_16x16x32_bf16 v[16:19], v[144:147], v[128:131], v[16:19]
    v_mfma_f32_16x16x32_bf16 v[20:23], v[144:147], v[132:135], v[20:23]
    v_mfma_f32_16x16x32_bf16 v[24:27], v[144:147], v[136:139], v[24:27]
    v_mfma_f32_16x16x32_bf16 v[28:31], v[144:147], v[140:143], v[28:31]
    s_waitcnt lgkmcnt(3)
    v_mfma_f32_16x16x32_bf16 v[32:35], v[148:151], v[128:131], v[32:35]
    v_mfma_f32_16x16x32_bf16 v[36:39], v[148:151], v[132:135], v[36:39]
    v_mfma_f32_16x16x32_bf16 v[40:43], v[148:151], v[136:139], v[40:43]
    v_mfma_f32_16x16x32_bf16 v[44:47], v[148:151], v[140:143], v[44:47]
    s_waitcnt lgkmcnt(2)
    v_mfma_f32_16x16x32_bf16 v[48:51], v[152:155], v[128:131], v[48:51]
    v_mfma_f32_16x16x32_bf16 v[52:55], v[152:155], v[132:135], v[52:55]
    v_mfma_f32_16x16x32_bf16 v[56:59], v[152:155], v[136:139], v[56:59]
    v_mfma_f32_16x16x32_bf16 v[60:63], v[152:155], v[140:143], v[60:63]
    s_waitcnt lgkmcnt(1)
    v_mfma_f32_16x16x32_bf16 v[64:67], v[156:159], v[128:131], v[64:67]
    v_mfma_f32_16x16x32_bf16 v[68:71], v[156:159], v[132:135], v[68:71]
    v_mfma_f32_16x16x32_bf16 v[72:75], v[156:159], v[136:139], v[72:75]
    v_mfma_f32_16x16x32_bf16 v[76:79], v[156:159], v[140:143], v[76:79]
    s_waitcnt lgkmcnt(0)
    v_mfma_f32_16x16x32_bf16 v[80:83], v[160:163], v[128:131], v[80:83]
    v_mfma_f32_16x16x32_bf16 v[84:87], v[160:163], v[132:135], v[84:87]
    v_mfma_f32_16x16x32_bf16 v[88:91], v[160:163], v[136:139], v[88:91]
    v_mfma_f32_16x16x32_bf16 v[92:95], v[160:163], v[140:143], v[92:95]
    s_setprio 3
    v_and_b32 v8, 15, v2
    v_mul_u32_u24 v8, 336, v8
    v_lshrrev_b32 v9, 4, v2
    v_lshl_add_u32 v8, v9, 4, v8
    v_add_u32 v8, s42, v8
    ds_write_b128 v8, v[16:19] offset:0
    ds_write_b128 v8, v[20:23] offset:5376
    ds_write_b128 v8, v[24:27] offset:10752
    ds_write_b128 v8, v[28:31] offset:16128
    ds_write_b128 v8, v[32:35] offset:64
    ds_write_b128 v8, v[36:39] offset:5440
    ds_write_b128 v8, v[40:43] offset:10816
    ds_write_b128 v8, v[44:47] offset:16192
    ds_write_b128 v8, v[48:51] offset:128
    ds_write_b128 v8, v[52:55] offset:5504
    ds_write_b128 v8, v[56:59] offset:10880
    ds_write_b128 v8, v[60:63] offset:16256
    ds_write_b128 v8, v[64:67] offset:192
    ds_write_b128 v8, v[68:71] offset:5568
    ds_write_b128 v8, v[72:75] offset:10944
    ds_write_b128 v8, v[76:79] offset:16320
    ds_write_b128 v8, v[80:83] offset:256
    ds_write_b128 v8, v[84:87] offset:5632
    ds_write_b128 v8, v[88:91] offset:11008
    ds_write_b128 v8, v[92:95] offset:16384

    s_waitcnt lgkmcnt(0)
    s_barrier
    s_endpgm
MK_B:
    v_and_b32 v3, 31, v2
    v_lshrrev_b32 v4, 5, v2
    v_bfe_u32 v5, v2, 1, 3
    v_xor_b32 v5, v5, v4
    v_lshlrev_b32 v5, 4, v5
    v_lshl_add_u32 v5, v3, 7, v5
    v_bfe_u32 v6, v2, 2, 2
    v_and_b32 v7, 3, v2
    v_bfe_u32 v14, v2, 4, 1
    v_lshl_add_u32 v15, v4, 3, v6
    s_sub_u32 s40, s33, 4
    s_lshl_b32 s42, s40, 12
    s_add_u32 s42, s42, 0
    v_mul_u32_u24 v12, 192, v15
    v_lshl_add_u32 v12, v14, 5, v12
    v_lshl_add_u32 v12, v7, 3, v12
    v_add_u32 v12, 32768, v12
    s_and_b32 s41, s40, 1
    s_mul_i32 s63, s41, 6144
    v_add_u32 v12, s63, v12
    s_lshl_b32 s63, s41, 6
    v_xor_b32 v14, s63, v5
    s_lshl_b32 s42, s40, 12
    v_add_u32 v8, s42, v14
    v_xor_b32 v9, 32, v8
    v_xor_b32 v10, 4096, v8
    v_xor_b32 v11, 4096, v9
    s_mov_b32 s43, s44
    v_mov_b32 v80, 0
    v_mov_b32 v81, 0
    v_mov_b32 v82, 0
    v_mov_b32 v83, 0
    v_mov_b32 v84, 0
    v_mov_b32 v85, 0
    v_mov_b32 v86, 0
    v_mov_b32 v87, 0
    v_mov_b32 v88, 0
    v_mov_b32 v89, 0
    v_mov_b32 v90, 0
    v_mov_b32 v91, 0
    v_mov_b32 v92, 0
    v_mov_b32 v93, 0
    v_mov_b32 v94, 0
    v_mov_b32 v95, 0
    v_mov_b32 v96, 0
    v_mov_b32 v97, 0
    v_mov_b32 v98, 0
    v_mov_b32 v99, 0
    v_mov_b32 v100, 0
    v_mov_b32 v101, 0
    v_mov_b32 v102, 0
    v_mov_b32 v103, 0
    v_mov_b32 v104, 0
    v_mov_b32 v105, 0
    v_mov_b32 v106, 0
    v_mov_b32 v107, 0
    v_mov_b32 v108, 0
    v_mov_b32 v109, 0
    v_mov_b32 v110, 0
    v_mov_b32 v111, 0
    v_mov_b32 v112, 0
    v_mov_b32 v113, 0
    v_mov_b32 v114, 0
    v_mov_b32 v115, 0
    v_mov_b32 v116, 0
    v_mov_b32 v117, 0
    v_mov_b32 v118, 0
    v_mov_b32 v119, 0
    v_mov_b32 v120, 0
    v_mov_b32 v121, 0
    v_mov_b32 v122, 0
    v_mov_b32 v123, 0
    v_mov_b32 v124, 0
    v_mov_b32 v125, 0
    v_mov_b32 v126, 0
    v_mov_b32 v127, 0
    s_waitcnt vmcnt(0)
    v_lshlrev_b32 v128, 16, v48
    v_and_b32 v129, 0xffff0000, v48
    v_lshlrev_b32 v130, 16, v49
    v_and_b32 v131, 0xffff0000, v49
    v_lshlrev_b32 v132, 16, v50
    v_and_b32 v133, 0xffff0000, v50
    v_lshlrev_b32 v134, 16, v51
    v_and_b32 v135, 0xffff0000, v51
    v_lshlrev_b32 v136, 16, v52
    v_and_b32 v137, 0xffff0000, v52
    v_lshlrev_b32 v138, 16, v53
    v_and_b32 v139, 0xffff0000, v53
    v_lshlrev_b32 v140, 16, v54
    v_and_b32 v141, 0xffff0000, v54
    v_lshlrev_b32 v142, 16, v55
    v_and_b32 v143, 0xffff0000, v55
    v_lshlrev_b32 v144, 16, v56
    v_and_b32 v145, 0xffff0000, v56
    v_lshlrev_b32 v146, 16, v57
    v_and_b32 v147, 0xffff0000, v57
    v_add_f32 v58, v128, v129
    v_add_f32 v59, v130, v131
    v_add_f32 v58, v58, v132
    v_add_f32 v59, v59, v133
    v_add_f32 v58, v58, v134
    v_add_f32 v59, v59, v135
    v_add_f32 v58, v58, v136
    v_add_f32 v59, v59, v137
    v_add_f32 v58, v58, v138
    v_add_f32 v59, v59, v139
    v_add_f32 v58, v58, v140
    v_add_f32 v59, v59, v141
    v_add_f32 v58, v58, v142
    v_add_f32 v59, v59, v143
    v_add_f32 v58, v58, v144
    v_add_f32 v59, v59, v145
    v_add_f32 v58, v58, v146
    v_add_f32 v59, v59, v147
    v_add_f32 v58, v58, v59
    s_nop 1
    v_add_f32_dpp v58, v58, v58 quad_perm:[1,0,3,2] row_mask:0xf bank_mask:0xf
    s_nop 1
    v_add_f32_dpp v58, v58, v58 quad_perm:[2,3,0,1] row_mask:0xf bank_mask:0xf
    s_nop 1
    v_add_f32_dpp v58, v58, v58 row_half_mirror row_mask:0xf bank_mask:0xf
    s_nop 1
    v_add_f32_dpp v58, v58, v58 row_mirror row_mask:0xf bank_mask:0xf
    v_mov_b32 v16, v58
    s_nop 1
    v_permlane16_swap_b32 v58, v16
    v_add_f32 v58, v58, v16
    v_mul_f32 v58, 0xbacccccd, v58
    v_add_f32 v128, v58, v128
    v_add_f32 v129, v58, v129
    v_add_f32 v130, v58, v130
    v_add_f32 v131, v58, v131
    v_add_f32 v132, v58, v132
    v_add_f32 v133, v58, v133
    v_add_f32 v134, v58, v134
    v_add_f32 v135, v58, v135
    v_add_f32 v136, v58, v136
    v_add_f32 v137, v58, v137
    v_add_f32 v138, v58, v138
    v_add_f32 v139, v58, v139
    v_add_f32 v140, v58, v140
    v_add_f32 v141, v58, v141
    v_add_f32 v142, v58, v142
    v_add_f32 v143, v58, v143
    v_add_f32 v144, v58, v144
    v_add_f32 v145, v58, v145
    v_add_f32 v146, v58, v146
    v_add_f32 v147, v58, v147
    v_mul_f32 v59, v128, v128
    v_mul_f32 v16, v129, v129
    v_fmac_f32 v59, v130, v130
    v_fmac_f32 v16, v131, v131
    v_fmac_f32 v59, v132, v132
    v_fmac_f32 v16, v133, v133
    v_fmac_f32 v59, v134, v134
    v_fmac_f32 v16, v135, v135
    v_fmac_f32 v59, v136, v136
    v_fmac_f32 v16, v137, v137
    v_fmac_f32 v59, v138, v138
    v_fmac_f32 v16, v139, v139
    v_fmac_f32 v59, v140, v140
    v_fmac_f32 v16, v141, v141
    v_fmac_f32 v59, v142, v142
    v_fmac_f32 v16, v143, v143
    v_fmac_f32 v59, v144, v144
    v_fmac_f32 v16, v145, v145
    v_fmac_f32 v59, v146, v146
    v_fmac_f32 v16, v147, v147
    v_add_f32 v59, v59, v16
    s_nop 1
    v_add_f32_dpp v59, v59, v59 quad_perm:[1,0,3,2] row_mask:0xf bank_mask:0xf
    s_nop 1
    v_add_f32_dpp v59, v59, v59 quad_perm:[2,3,0,1] row_mask:0xf bank_mask:0xf
    s_nop 1
    v_add_f32_dpp v59, v59, v59 row_half_mirror row_mask:0xf bank_mask:0xf
    s_nop 1
    v_add_f32_dpp v59, v59, v59 row_mirror row_mask:0xf bank_mask:0xf
    v_mov_b32 v16, v59
    s_nop 1
    v_permlane16_swap_b32 v59, v16
    v_add_f32 v59, v59, v16
    v_mov_b32 v16, 0x3727c5ac
    v_fmac_f32 v16, 0x3acccccd, v59
    v_rsq_f32 v59, v16
    v_lshlrev_b32 v17, 3, v4
    s_lshl_b32 s45, s43, 3
    s_add_u32 s45, s45, 0x17b8000
    buffer_store_dwordx2 v[58:59], v17, s[16:19], s45 offen sc1
    v_mov_b32 v128, 0
    v_mov_b32 v129, 0
    v_mov_b32 v130, 0
    v_mov_b32 v131, 0
    v_mov_b32 v132, 0
    v_mov_b32 v133, 0
    v_mov_b32 v134, 0
    v_mov_b32 v135, 0
    v_mov_b32 v136, 0
    v_mov_b32 v137, 0
    v_mov_b32 v138, 0
    v_mov_b32 v139, 0
    v_mov_b32 v140, 0
    v_mov_b32 v141, 0
    v_mov_b32 v142, 0
    v_mov_b32 v143, 0
    v_mov_b32 v144, 0
    v_mov_b32 v145, 0
    v_mov_b32 v146, 0
    v_mov_b32 v147, 0
    v_mov_b32 v148, 0
    v_mov_b32 v149, 0
    v_mov_b32 v150, 0
    v_mov_b32 v151, 0
    v_mov_b32 v152, 0
    v_mov_b32 v153, 0
    v_mov_b32 v154, 0
    v_mov_b32 v155, 0
    v_mov_b32 v156, 0
    v_mov_b32 v157, 0
    v_mov_b32 v158, 0
    v_mov_b32 v159, 0
    v_mov_b32 v56, 0
    v_mov_b32 v57, 0
    v_mov_b32 v58, 0
    v_mov_b32 v59, 0
    v_mov_b32 v60, 0
    v_mov_b32 v61, 0
    v_mov_b32 v62, 0
    v_mov_b32 v63, 0
    v_mov_b32 v64, 0
    v_mov_b32 v65, 0
    v_mov_b32 v66, 0
    v_mov_b32 v67, 0
    v_mov_b32 v68, 0
    v_mov_b32 v69, 0
    v_mov_b32 v70, 0
    v_mov_b32 v71, 0

    s_setprio 0
    s_barrier
    s_mov_b32 s60, 0
    s_mov_b32 s61, 10
    ds_read_b128 v[16:19], v8
    ds_read_b64_tr_b16 v[24:25], v12 offset:0
    ds_read_b64_tr_b16 v[26:27], v12 offset:768
    ds_read_b128 v[20:23], v10
    ds_read_b64_tr_b16 v[28:29], v12 offset:64
    ds_read_b64_tr_b16 v[30:31], v12 offset:832
    ds_read_b64_tr_b16 v[32:33], v12 offset:128
    ds_read_b64_tr_b16 v[34:35], v12 offset:896
.p2align 4
MK_BL:
    s_waitcnt lgkmcnt(0)
    v_mfma_f32_32x32x16_bf16 v[80:95], v[24:27], v[16:19], v[80:95]
    ds_read_b128 v[36:39], v9
    ds_read_b64_tr_b16 v[44:45], v12 offset:3072
    v_mfma_f32_32x32x16_bf16 v[56:71], v[24:27], v[20:23], v[56:71]
    ds_read_b64_tr_b16 v[46:47], v12 offset:3840
    v_mfma_f32_32x32x16_bf16 v[96:111], v[28:31], v[16:19], v[96:111]
    ds_read_b128 v[40:43], v11
    v_mfma_f32_32x32x16_bf16 v[128:143], v[28:31], v[20:23], v[128:143]
    ds_read_b64_tr_b16 v[48:49], v12 offset:3136
    ds_read_b64_tr_b16 v[50:51], v12 offset:3904
    v_mfma_f32_32x32x16_bf16 v[112:127], v[32:35], v[16:19], v[112:127]
    ds_read_b64_tr_b16 v[52:53], v12 offset:3200
    v_mfma_f32_32x32x16_bf16 v[144:159], v[32:35], v[20:23], v[144:159]
    ds_read_b64_tr_b16 v[54:55], v12 offset:3968
    s_add_u32 s60, s60, 1
    s_cmp_eq_u32 s60, 3
    s_mov_b32 s62, 45056
    s_cselect_b32 s62, 0xfffea000, s62
    s_cselect_b32 s60, 0, s60
    v_add_u32 v8, s62, v8
    v_add_u32 v9, s62, v9
    v_add_u32 v10, s62, v10
    v_add_u32 v11, s62, v11
    v_add_u32 v12, s62, v12
    s_cmp_lg_u32 s61, 9
    s_cbranch_scc1 MK_BL_NH
    s_waitcnt vmcnt(0)

MK_BL_NH:
    s_waitcnt lgkmcnt(0)
    s_barrier
    v_mfma_f32_32x32x16_bf16 v[80:95], v[44:47], v[36:39], v[80:95]
    ds_read_b128 v[16:19], v8
    ds_read_b64_tr_b16 v[24:25], v12 offset:0
    v_mfma_f32_32x32x16_bf16 v[56:71], v[44:47], v[40:43], v[56:71]
    ds_read_b64_tr_b16 v[26:27], v12 offset:768
    v_mfma_f32_32x32x16_bf16 v[96:111], v[48:51], v[36:39], v[96:111]
    ds_read_b128 v[20:23], v10
    v_mfma_f32_32x32x16_bf16 v[128:143], v[48:51], v[40:43], v[128:143]
    ds_read_b64_tr_b16 v[28:29], v12 offset:64
    ds_read_b64_tr_b16 v[30:31], v12 offset:832
    v_mfma_f32_32x32x16_bf16 v[112:127], v[52:55], v[36:39], v[112:127]
    ds_read_b64_tr_b16 v[32:33], v12 offset:128
    v_mfma_f32_32x32x16_bf16 v[144:159], v[52:55], v[40:43], v[144:159]
    ds_read_b64_tr_b16 v[34:35], v12 offset:896
    s_sub_u32 s61, s61, 1
    s_cmp_lg_u32 s61, 0
    s_cbranch_scc1 MK_BL
    s_waitcnt lgkmcnt(0)
    s_setprio 0

    v_lshlrev_b32 v13, 4, v2
    s_xor_b32 s50, s40, 1
    s_mul_i32 s51, s50, 24576
    v_add_u32 v8, s51, v13
    s_mul_i32 s51, s40, 24576
    v_add_u32 v9, s51, v13
    s_lshl_b32 s50, s50, 2
    s_add_u32 s50, s50, 162944
    v_mov_b32 v10, s50
    s_lshl_b32 s50, s40, 2
    s_add_u32 s50, s50, 162944
    v_mov_b32 v11, s50
    ds_write_b128 v8, v[56:59] offset:0
    ds_write_b128 v8, v[60:63] offset:1024
    ds_write_b128 v8, v[64:67] offset:2048
    ds_write_b128 v8, v[68:71] offset:3072
    ds_write_b128 v8, v[128:131] offset:4096
    ds_write_b128 v8, v[132:135] offset:5120
    ds_write_b128 v8, v[136:139] offset:6144
    ds_write_b128 v8, v[140:143] offset:7168
    ds_write_b128 v8, v[144:147] offset:8192
    ds_write_b128 v8, v[148:151] offset:9216
    ds_write_b128 v8, v[152:155] offset:10240
    ds_write_b128 v8, v[156:159] offset:11264
    ds_write_b32 v10, v10
MK_BX:
    ds_read_b32 v12, v11
    s_waitcnt lgkmcnt(0)
    v_cmp_eq_u32 vcc, 0, v12
    s_cbranch_vccnz MK_BX
    ds_read_b128 v[56:59], v9 offset:0
    ds_read_b128 v[60:63], v9 offset:1024
    ds_read_b128 v[64:67], v9 offset:2048
    ds_read_b128 v[68:71], v9 offset:3072
    ds_read_b128 v[128:131], v9 offset:4096
    ds_read_b128 v[132:135], v9 offset:5120
    ds_read_b128 v[136:139], v9 offset:6144
    ds_read_b128 v[140:143], v9 offset:7168
    ds_read_b128 v[144:147], v9 offset:8192
    ds_read_b128 v[148:151], v9 offset:9216
    ds_read_b128 v[152:155], v9 offset:10240
    ds_read_b128 v[156:159], v9 offset:11264
    s_waitcnt lgkmcnt(8)
    v_pk_add_f32 v[80:81], v[80:81], v[56:57]
    v_pk_add_f32 v[82:83], v[82:83], v[58:59]
    v_pk_add_f32 v[84:85], v[84:85], v[60:61]
    v_pk_add_f32 v[86:87], v[86:87], v[62:63]
    v_pk_add_f32 v[88:89], v[88:89], v[64:65]
    v_pk_add_f32 v[90:91], v[90:91], v[66:67]
    v_pk_add_f32 v[92:93], v[92:93], v[68:69]
    v_pk_add_f32 v[94:95], v[94:95], v[70:71]
    s_waitcnt lgkmcnt(4)
    v_pk_add_f32 v[96:97], v[96:97], v[128:129]
    v_pk_add_f32 v[98:99], v[98:99], v[130:131]
    v_pk_add_f32 v[100:101], v[100:101], v[132:133]
    v_pk_add_f32 v[102:103], v[102:103], v[134:135]
    v_pk_add_f32 v[104:105], v[104:105], v[136:137]
    v_pk_add_f32 v[106:107], v[106:107], v[138:139]
    v_pk_add_f32 v[108:109], v[108:109], v[140:141]
    v_pk_add_f32 v[110:111], v[110:111], v[142:143]
    s_waitcnt lgkmcnt(0)
    v_pk_add_f32 v[112:113], v[112:113], v[144:145]
    v_pk_add_f32 v[114:115], v[114:115], v[146:147]
    v_pk_add_f32 v[116:117], v[116:117], v[148:149]
    v_pk_add_f32 v[118:119], v[118:119], v[150:151]
    v_pk_add_f32 v[120:121], v[120:121], v[152:153]
    v_pk_add_f32 v[122:123], v[122:123], v[154:155]
    v_pk_add_f32 v[124:125], v[124:125], v[156:157]
    v_pk_add_f32 v[126:127], v[126:127], v[158:159]
    v_lshlrev_b32 v14, 4, v4
    v_lshlrev_b32 v15, 2, v3
    v_lshlrev_b32 v13, 4, v2
    s_lshl_b32 s55, s40, 7
    s_add_u32 s55, s55, 136192
    v_add_u32 v15, s55, v15
    ds_read_b32 v8, v15
    ds_read_b32 v9, v15 offset:512
    v_add_u32 v14, 137728, v14
    v_mov_b32 v10, 162836
    ds_read_b32 v66, v10
    ds_read_b128 v[16:19], v14 offset:0
    ds_read_b128 v[20:23], v14 offset:32
    ds_read_b128 v[24:27], v14 offset:64
    ds_read_b128 v[28:31], v14 offset:96
    ds_read_b128 v[32:35], v14 offset:128
    ds_read_b128 v[36:39], v14 offset:160
    ds_read_b128 v[40:43], v14 offset:192
    ds_read_b128 v[44:47], v14 offset:224
    ds_read_b128 v[48:51], v14 offset:256
    ds_read_b128 v[52:55], v14 offset:288
    ds_read_b128 v[56:59], v14 offset:320
    ds_read_b128 v[60:63], v14 offset:352
    v_mov_b32 v4, 0xbdd2d3e8
    v_mov_b32 v5, 0xbdd2d3e8
    v_mov_b32 v6, 0xc0135761
    v_mov_b32 v7, 0xc0135761
    s_lshl_b32 s54, s36, 2
    s_add_u32 s54, s54, s40
    s_waitcnt lgkmcnt(0)
    v_pk_fma_f32 v[80:81], v[16:17], v[8:9], v[80:81] op_sel_hi:[1,0,1]
    v_pk_fma_f32 v[82:83], v[18:19], v[8:9], v[82:83] op_sel_hi:[1,0,1]
    v_pk_fma_f32 v[84:85], v[20:21], v[8:9], v[84:85] op_sel_hi:[1,0,1]
    v_pk_fma_f32 v[86:87], v[22:23], v[8:9], v[86:87] op_sel_hi:[1,0,1]
    v_pk_fma_f32 v[88:89], v[24:25], v[8:9], v[88:89] op_sel_hi:[1,0,1]
    v_pk_fma_f32 v[90:91], v[26:27], v[8:9], v[90:91] op_sel_hi:[1,0,1]
    v_pk_fma_f32 v[92:93], v[28:29], v[8:9], v[92:93] op_sel_hi:[1,0,1]
    v_pk_fma_f32 v[94:95], v[30:31], v[8:9], v[94:95] op_sel_hi:[1,0,1]
    v_pk_mul_f32 v[80:81], v[80:81], v[8:9] op_sel:[0,1]
    v_pk_mul_f32 v[82:83], v[82:83], v[8:9] op_sel:[0,1]
    v_pk_mul_f32 v[84:85], v[84:85], v[8:9] op_sel:[0,1]
    v_pk_mul_f32 v[86:87], v[86:87], v[8:9] op_sel:[0,1]
    v_pk_mul_f32 v[88:89], v[88:89], v[8:9] op_sel:[0,1]
    v_pk_mul_f32 v[90:91], v[90:91], v[8:9] op_sel:[0,1]
    v_pk_mul_f32 v[92:93], v[92:93], v[8:9] op_sel:[0,1]
    v_pk_mul_f32 v[94:95], v[94:95], v[8:9] op_sel:[0,1]
    v_pk_mul_f32 v[128:129], v[80:81], v[80:81]
    v_pk_mul_f32 v[130:131], v[82:83], v[82:83]
    v_pk_mul_f32 v[132:133], v[84:85], v[84:85]
    v_pk_mul_f32 v[134:135], v[86:87], v[86:87]
    v_pk_fma_f32 v[128:129], v[128:129], v[4:5], v[6:7]
    v_pk_fma_f32 v[130:131], v[130:131], v[4:5], v[6:7]
    v_pk_fma_f32 v[132:133], v[132:133], v[4:5], v[6:7]
    v_pk_fma_f32 v[134:135], v[134:135], v[4:5], v[6:7]
    v_pk_mul_f32 v[128:129], v[128:129], v[80:81]
    v_pk_mul_f32 v[130:131], v[130:131], v[82:83]
    v_pk_mul_f32 v[132:133], v[132:133], v[84:85]
    v_pk_mul_f32 v[134:135], v[134:135], v[86:87]
    v_exp_f32 v128, v128
    v_exp_f32 v129, v129
    v_exp_f32 v130, v130
    v_exp_f32 v131, v131
    v_exp_f32 v132, v132
    v_exp_f32 v133, v133
    v_exp_f32 v134, v134
    v_exp_f32 v135, v135
    v_pk_add_f32 v[128:129], v[128:129], 1.0 op_sel_hi:[1,0]
    v_pk_add_f32 v[130:131], v[130:131], 1.0 op_sel_hi:[1,0]
    v_pk_add_f32 v[132:133], v[132:133], 1.0 op_sel_hi:[1,0]
    v_pk_add_f32 v[134:135], v[134:135], 1.0 op_sel_hi:[1,0]
    v_rcp_f32 v128, v128
    v_rcp_f32 v129, v129
    v_rcp_f32 v130, v130
    v_rcp_f32 v131, v131
    v_rcp_f32 v132, v132
    v_rcp_f32 v133, v133
    v_rcp_f32 v134, v134
    v_rcp_f32 v135, v135
    v_pk_mul_f32 v[80:81], v[80:81], v[128:129]
    v_pk_mul_f32 v[82:83], v[82:83], v[130:131]
    v_pk_mul_f32 v[84:85], v[84:85], v[132:133]
    v_pk_mul_f32 v[86:87], v[86:87], v[134:135]
    v_pk_mul_f32 v[128:129], v[88:89], v[88:89]
    v_pk_mul_f32 v[130:131], v[90:91], v[90:91]
    v_pk_mul_f32 v[132:133], v[92:93], v[92:93]
    v_pk_mul_f32 v[134:135], v[94:95], v[94:95]
    v_pk_fma_f32 v[128:129], v[128:129], v[4:5], v[6:7]
    v_pk_fma_f32 v[130:131], v[130:131], v[4:5], v[6:7]
    v_pk_fma_f32 v[132:133], v[132:133], v[4:5], v[6:7]
    v_pk_fma_f32 v[134:135], v[134:135], v[4:5], v[6:7]
    v_pk_mul_f32 v[128:129], v[128:129], v[88:89]
    v_pk_mul_f32 v[130:131], v[130:131], v[90:91]
    v_pk_mul_f32 v[132:133], v[132:133], v[92:93]
    v_pk_mul_f32 v[134:135], v[134:135], v[94:95]
    v_exp_f32 v128, v128
    v_exp_f32 v129, v129
    v_exp_f32 v130, v130
    v_exp_f32 v131, v131
    v_exp_f32 v132, v132
    v_exp_f32 v133, v133
    v_exp_f32 v134, v134
    v_exp_f32 v135, v135
    v_pk_add_f32 v[128:129], v[128:129], 1.0 op_sel_hi:[1,0]
    v_pk_add_f32 v[130:131], v[130:131], 1.0 op_sel_hi:[1,0]
    v_pk_add_f32 v[132:133], v[132:133], 1.0 op_sel_hi:[1,0]
    v_pk_add_f32 v[134:135], v[134:135], 1.0 op_sel_hi:[1,0]
    v_rcp_f32 v128, v128
    v_rcp_f32 v129, v129
    v_rcp_f32 v130, v130
    v_rcp_f32 v131, v131
    v_rcp_f32 v132, v132
    v_rcp_f32 v133, v133
    v_rcp_f32 v134, v134
    v_rcp_f32 v135, v135
    v_pk_mul_f32 v[88:89], v[88:89], v[128:129]
    v_pk_mul_f32 v[90:91], v[90:91], v[130:131]
    v_pk_mul_f32 v[92:93], v[92:93], v[132:133]
    v_pk_mul_f32 v[94:95], v[94:95], v[134:135]
    v_pk_fma_f32 v[96:97], v[32:33], v[8:9], v[96:97] op_sel_hi:[1,0,1]
    v_pk_fma_f32 v[98:99], v[34:35], v[8:9], v[98:99] op_sel_hi:[1,0,1]
    v_pk_fma_f32 v[100:101], v[36:37], v[8:9], v[100:101] op_sel_hi:[1,0,1]
    v_pk_fma_f32 v[102:103], v[38:39], v[8:9], v[102:103] op_sel_hi:[1,0,1]
    v_pk_fma_f32 v[104:105], v[40:41], v[8:9], v[104:105] op_sel_hi:[1,0,1]
    v_pk_fma_f32 v[106:107], v[42:43], v[8:9], v[106:107] op_sel_hi:[1,0,1]
    v_pk_fma_f32 v[108:109], v[44:45], v[8:9], v[108:109] op_sel_hi:[1,0,1]
    v_pk_fma_f32 v[110:111], v[46:47], v[8:9], v[110:111] op_sel_hi:[1,0,1]
    v_pk_mul_f32 v[96:97], v[96:97], v[8:9] op_sel:[0,1]
    v_pk_mul_f32 v[98:99], v[98:99], v[8:9] op_sel:[0,1]
    v_pk_mul_f32 v[100:101], v[100:101], v[8:9] op_sel:[0,1]
    v_pk_mul_f32 v[102:103], v[102:103], v[8:9] op_sel:[0,1]
    v_pk_mul_f32 v[104:105], v[104:105], v[8:9] op_sel:[0,1]
    v_pk_mul_f32 v[106:107], v[106:107], v[8:9] op_sel:[0,1]
    v_pk_mul_f32 v[108:109], v[108:109], v[8:9] op_sel:[0,1]
    v_pk_mul_f32 v[110:111], v[110:111], v[8:9] op_sel:[0,1]
    v_pk_mul_f32 v[128:129], v[96:97], v[96:97]
    v_pk_mul_f32 v[130:131], v[98:99], v[98:99]
    v_pk_mul_f32 v[132:133], v[100:101], v[100:101]
    v_pk_mul_f32 v[134:135], v[102:103], v[102:103]
    v_pk_fma_f32 v[128:129], v[128:129], v[4:5], v[6:7]
    v_pk_fma_f32 v[130:131], v[130:131], v[4:5], v[6:7]
    v_pk_fma_f32 v[132:133], v[132:133], v[4:5], v[6:7]
    v_pk_fma_f32 v[134:135], v[134:135], v[4:5], v[6:7]
    v_pk_mul_f32 v[128:129], v[128:129], v[96:97]
    v_pk_mul_f32 v[130:131], v[130:131], v[98:99]
    v_pk_mul_f32 v[132:133], v[132:133], v[100:101]
    v_pk_mul_f32 v[134:135], v[134:135], v[102:103]
    v_exp_f32 v128, v128
    v_exp_f32 v129, v129
    v_exp_f32 v130, v130
    v_exp_f32 v131, v131
    v_exp_f32 v132, v132
    v_exp_f32 v133, v133
    v_exp_f32 v134, v134
    v_exp_f32 v135, v135
    v_pk_add_f32 v[128:129], v[128:129], 1.0 op_sel_hi:[1,0]
    v_pk_add_f32 v[130:131], v[130:131], 1.0 op_sel_hi:[1,0]
    v_pk_add_f32 v[132:133], v[132:133], 1.0 op_sel_hi:[1,0]
    v_pk_add_f32 v[134:135], v[134:135], 1.0 op_sel_hi:[1,0]
    v_rcp_f32 v128, v128
    v_rcp_f32 v129, v129
    v_rcp_f32 v130, v130
    v_rcp_f32 v131, v131
    v_rcp_f32 v132, v132
    v_rcp_f32 v133, v133
    v_rcp_f32 v134, v134
    v_rcp_f32 v135, v135
    v_pk_mul_f32 v[96:97], v[96:97], v[128:129]
    v_pk_mul_f32 v[98:99], v[98:99], v[130:131]
    v_pk_mul_f32 v[100:101], v[100:101], v[132:133]
    v_pk_mul_f32 v[102:103], v[102:103], v[134:135]
    v_pk_mul_f32 v[128:129], v[104:105], v[104:105]
    v_pk_mul_f32 v[130:131], v[106:107], v[106:107]
    v_pk_mul_f32 v[132:133], v[108:109], v[108:109]
    v_pk_mul_f32 v[134:135], v[110:111], v[110:111]
    v_pk_fma_f32 v[128:129], v[128:129], v[4:5], v[6:7]
    v_pk_fma_f32 v[130:131], v[130:131], v[4:5], v[6:7]
    v_pk_fma_f32 v[132:133], v[132:133], v[4:5], v[6:7]
    v_pk_fma_f32 v[134:135], v[134:135], v[4:5], v[6:7]
    v_pk_mul_f32 v[128:129], v[128:129], v[104:105]
    v_pk_mul_f32 v[130:131], v[130:131], v[106:107]
    v_pk_mul_f32 v[132:133], v[132:133], v[108:109]
    v_pk_mul_f32 v[134:135], v[134:135], v[110:111]
    v_exp_f32 v128, v128
    v_exp_f32 v129, v129
    v_exp_f32 v130, v130
    v_exp_f32 v131, v131
    v_exp_f32 v132, v132
    v_exp_f32 v133, v133
    v_exp_f32 v134, v134
    v_exp_f32 v135, v135
    v_pk_add_f32 v[128:129], v[128:129], 1.0 op_sel_hi:[1,0]
    v_pk_add_f32 v[130:131], v[130:131], 1.0 op_sel_hi:[1,0]
    v_pk_add_f32 v[132:133], v[132:133], 1.0 op_sel_hi:[1,0]
    v_pk_add_f32 v[134:135], v[134:135], 1.0 op_sel_hi:[1,0]
    v_rcp_f32 v128, v128
    v_rcp_f32 v129, v129
    v_rcp_f32 v130, v130
    v_rcp_f32 v131, v131
    v_rcp_f32 v132, v132
    v_rcp_f32 v133, v133
    v_rcp_f32 v134, v134
    v_rcp_f32 v135, v135
    v_pk_mul_f32 v[104:105], v[104:105], v[128:129]
    v_pk_mul_f32 v[106:107], v[106:107], v[130:131]
    v_pk_mul_f32 v[108:109], v[108:109], v[132:133]
    v_pk_mul_f32 v[110:111], v[110:111], v[134:135]
    v_pk_fma_f32 v[112:113], v[48:49], v[8:9], v[112:113] op_sel_hi:[1,0,1]
    v_pk_fma_f32 v[114:115], v[50:51], v[8:9], v[114:115] op_sel_hi:[1,0,1]
    v_pk_fma_f32 v[116:117], v[52:53], v[8:9], v[116:117] op_sel_hi:[1,0,1]
    v_pk_fma_f32 v[118:119], v[54:55], v[8:9], v[118:119] op_sel_hi:[1,0,1]
    v_pk_fma_f32 v[120:121], v[56:57], v[8:9], v[120:121] op_sel_hi:[1,0,1]
    v_pk_fma_f32 v[122:123], v[58:59], v[8:9], v[122:123] op_sel_hi:[1,0,1]
    v_pk_fma_f32 v[124:125], v[60:61], v[8:9], v[124:125] op_sel_hi:[1,0,1]
    v_pk_fma_f32 v[126:127], v[62:63], v[8:9], v[126:127] op_sel_hi:[1,0,1]
    v_pk_mul_f32 v[112:113], v[112:113], v[8:9] op_sel:[0,1]
    v_pk_mul_f32 v[114:115], v[114:115], v[8:9] op_sel:[0,1]
    v_pk_mul_f32 v[116:117], v[116:117], v[8:9] op_sel:[0,1]
    v_pk_mul_f32 v[118:119], v[118:119], v[8:9] op_sel:[0,1]
    v_pk_mul_f32 v[120:121], v[120:121], v[8:9] op_sel:[0,1]
    v_pk_mul_f32 v[122:123], v[122:123], v[8:9] op_sel:[0,1]
    v_pk_mul_f32 v[124:125], v[124:125], v[8:9] op_sel:[0,1]
    v_pk_mul_f32 v[126:127], v[126:127], v[8:9] op_sel:[0,1]
    v_pk_mul_f32 v[128:129], v[112:113], v[112:113]
    v_pk_mul_f32 v[130:131], v[114:115], v[114:115]
    v_pk_mul_f32 v[132:133], v[116:117], v[116:117]
    v_pk_mul_f32 v[134:135], v[118:119], v[118:119]
    v_pk_fma_f32 v[128:129], v[128:129], v[4:5], v[6:7]
    v_pk_fma_f32 v[130:131], v[130:131], v[4:5], v[6:7]
    v_pk_fma_f32 v[132:133], v[132:133], v[4:5], v[6:7]
    v_pk_fma_f32 v[134:135], v[134:135], v[4:5], v[6:7]
    v_pk_mul_f32 v[128:129], v[128:129], v[112:113]
    v_pk_mul_f32 v[130:131], v[130:131], v[114:115]
    v_pk_mul_f32 v[132:133], v[132:133], v[116:117]
    v_pk_mul_f32 v[134:135], v[134:135], v[118:119]
    v_exp_f32 v128, v128
    v_exp_f32 v129, v129
    v_exp_f32 v130, v130
    v_exp_f32 v131, v131
    v_exp_f32 v132, v132
    v_exp_f32 v133, v133
    v_exp_f32 v134, v134
    v_exp_f32 v135, v135
    v_pk_add_f32 v[128:129], v[128:129], 1.0 op_sel_hi:[1,0]
    v_pk_add_f32 v[130:131], v[130:131], 1.0 op_sel_hi:[1,0]
    v_pk_add_f32 v[132:133], v[132:133], 1.0 op_sel_hi:[1,0]
    v_pk_add_f32 v[134:135], v[134:135], 1.0 op_sel_hi:[1,0]
    v_rcp_f32 v128, v128
    v_rcp_f32 v129, v129
    v_rcp_f32 v130, v130
    v_rcp_f32 v131, v131
    v_rcp_f32 v132, v132
    v_rcp_f32 v133, v133
    v_rcp_f32 v134, v134
    v_rcp_f32 v135, v135
    v_pk_mul_f32 v[112:113], v[112:113], v[128:129]
    v_pk_mul_f32 v[114:115], v[114:115], v[130:131]
    v_pk_mul_f32 v[116:117], v[116:117], v[132:133]
    v_pk_mul_f32 v[118:119], v[118:119], v[134:135]
    v_pk_mul_f32 v[128:129], v[120:121], v[120:121]
    v_pk_mul_f32 v[130:131], v[122:123], v[122:123]
    v_pk_mul_f32 v[132:133], v[124:125], v[124:125]
    v_pk_mul_f32 v[134:135], v[126:127], v[126:127]
    v_pk_fma_f32 v[128:129], v[128:129], v[4:5], v[6:7]
    v_pk_fma_f32 v[130:131], v[130:131], v[4:5], v[6:7]
    v_pk_fma_f32 v[132:133], v[132:133], v[4:5], v[6:7]
    v_pk_fma_f32 v[134:135], v[134:135], v[4:5], v[6:7]
    v_pk_mul_f32 v[128:129], v[128:129], v[120:121]
    v_pk_mul_f32 v[130:131], v[130:131], v[122:123]
    v_pk_mul_f32 v[132:133], v[132:133], v[124:125]
    v_pk_mul_f32 v[134:135], v[134:135], v[126:127]
    v_exp_f32 v128, v128
    v_exp_f32 v129, v129
    v_exp_f32 v130, v130
    v_exp_f32 v131, v131
    v_exp_f32 v132, v132
    v_exp_f32 v133, v133
    v_exp_f32 v134, v134
    v_exp_f32 v135, v135
    v_pk_add_f32 v[128:129], v[128:129], 1.0 op_sel_hi:[1,0]
    v_pk_add_f32 v[130:131], v[130:131], 1.0 op_sel_hi:[1,0]
    v_pk_add_f32 v[132:133], v[132:133], 1.0 op_sel_hi:[1,0]
    v_pk_add_f32 v[134:135], v[134:135], 1.0 op_sel_hi:[1,0]
    v_rcp_f32 v128, v128
    v_rcp_f32 v129, v129
    v_rcp_f32 v130, v130
    v_rcp_f32 v131, v131
    v_rcp_f32 v132, v132
    v_rcp_f32 v133, v133
    v_rcp_f32 v134, v134
    v_rcp_f32 v135, v135
    v_pk_mul_f32 v[120:121], v[120:121], v[128:129]
    v_pk_mul_f32 v[122:123], v[122:123], v[130:131]
    v_pk_mul_f32 v[124:125], v[124:125], v[132:133]
    v_pk_mul_f32 v[126:127], v[126:127], v[134:135]
    s_cmp_ge_u32 s32, 8
    s_cbranch_scc1 MK_B_Z2
    v_cvt_pk_bf16_f32 v140, v80, v81
    v_cvt_pk_bf16_f32 v141, v82, v83
    v_cvt_pk_bf16_f32 v142, v84, v85
    v_cvt_pk_bf16_f32 v143, v86, v87
    v_cvt_pk_bf16_f32 v144, v88, v89
    v_cvt_pk_bf16_f32 v145, v90, v91
    v_cvt_pk_bf16_f32 v146, v92, v93
    v_cvt_pk_bf16_f32 v147, v94, v95
    v_cvt_pk_bf16_f32 v148, v96, v97
    v_cvt_pk_bf16_f32 v149, v98, v99
    v_cvt_pk_bf16_f32 v150, v100, v101
    v_cvt_pk_bf16_f32 v151, v102, v103
    v_cvt_pk_bf16_f32 v152, v104, v105
    v_cvt_pk_bf16_f32 v153, v106, v107
    v_cvt_pk_bf16_f32 v154, v108, v109
    v_cvt_pk_bf16_f32 v155, v110, v111
    v_cvt_pk_bf16_f32 v156, v112, v113
    v_cvt_pk_bf16_f32 v157, v114, v115
    v_cvt_pk_bf16_f32 v158, v116, v117
    v_cvt_pk_bf16_f32 v159, v118, v119
    v_cvt_pk_bf16_f32 v160, v120, v121
    v_cvt_pk_bf16_f32 v161, v122, v123
    v_cvt_pk_bf16_f32 v162, v124, v125
    v_cvt_pk_bf16_f32 v163, v126, v127
    s_mul_i32 s55, s54, 24
    s_mul_i32 s56, s32, 3
    s_add_u32 s55, s55, s56
    s_lshl_b32 s55, s55, 11
    s_add_u32 s55, s55, 0x780000
    s_branch MK_B_FIN
MK_B_Z2:
    v_pk_add_f32 v[16:17], v[80:81], v[82:83]
    v_pk_mul_f32 v[18:19], v[80:81], v[80:81]
    v_pk_add_f32 v[20:21], v[84:85], v[86:87]
    v_pk_mul_f32 v[22:23], v[82:83], v[82:83]
    v_pk_fma_f32 v[18:19], v[84:85], v[84:85], v[18:19]
    v_pk_fma_f32 v[22:23], v[86:87], v[86:87], v[22:23]
    v_pk_add_f32 v[16:17], v[16:17], v[88:89]
    v_pk_fma_f32 v[18:19], v[88:89], v[88:89], v[18:19]
    v_pk_add_f32 v[20:21], v[20:21], v[90:91]
    v_pk_fma_f32 v[22:23], v[90:91], v[90:91], v[22:23]
    v_pk_add_f32 v[16:17], v[16:17], v[92:93]
    v_pk_fma_f32 v[18:19], v[92:93], v[92:93], v[18:19]
    v_pk_add_f32 v[20:21], v[20:21], v[94:95]
    v_pk_fma_f32 v[22:23], v[94:95], v[94:95], v[22:23]
    v_pk_add_f32 v[16:17], v[16:17], v[96:97]
    v_pk_fma_f32 v[18:19], v[96:97], v[96:97], v[18:19]
    v_pk_add_f32 v[20:21], v[20:21], v[98:99]
    v_pk_fma_f32 v[22:23], v[98:99], v[98:99], v[22:23]
    v_pk_add_f32 v[16:17], v[16:17], v[100:101]
    v_pk_fma_f32 v[18:19], v[100:101], v[100:101], v[18:19]
    v_pk_add_f32 v[20:21], v[20:21], v[102:103]
    v_pk_fma_f32 v[22:23], v[102:103], v[102:103], v[22:23]
    v_pk_add_f32 v[16:17], v[16:17], v[104:105]
    v_pk_fma_f32 v[18:19], v[104:105], v[104:105], v[18:19]
    v_pk_add_f32 v[20:21], v[20:21], v[106:107]
    v_pk_fma_f32 v[22:23], v[106:107], v[106:107], v[22:23]
    v_pk_add_f32 v[16:17], v[16:17], v[108:109]
    v_pk_fma_f32 v[18:19], v[108:109], v[108:109], v[18:19]
    v_pk_add_f32 v[20:21], v[20:21], v[110:111]
    v_pk_fma_f32 v[22:23], v[110:111], v[110:111], v[22:23]
    v_pk_add_f32 v[16:17], v[16:17], v[112:113]
    v_pk_fma_f32 v[18:19], v[112:113], v[112:113], v[18:19]
    v_pk_add_f32 v[20:21], v[20:21], v[114:115]
    v_pk_fma_f32 v[22:23], v[114:115], v[114:115], v[22:23]
    v_pk_add_f32 v[16:17], v[16:17], v[116:117]
    v_pk_fma_f32 v[18:19], v[116:117], v[116:117], v[18:19]
    v_pk_add_f32 v[20:21], v[20:21], v[118:119]
    v_pk_fma_f32 v[22:23], v[118:119], v[118:119], v[22:23]
    v_pk_add_f32 v[16:17], v[16:17], v[120:121]
    v_pk_fma_f32 v[18:19], v[120:121], v[120:121], v[18:19]
    v_pk_add_f32 v[20:21], v[20:21], v[122:123]
    v_pk_fma_f32 v[22:23], v[122:123], v[122:123], v[22:23]
    v_pk_add_f32 v[16:17], v[16:17], v[124:125]
    v_pk_fma_f32 v[18:19], v[124:125], v[124:125], v[18:19]
    v_pk_add_f32 v[20:21], v[20:21], v[126:127]
    v_pk_fma_f32 v[22:23], v[126:127], v[126:127], v[22:23]
    v_pk_add_f32 v[16:17], v[16:17], v[20:21]
    v_pk_add_f32 v[18:19], v[18:19], v[22:23]
    v_mov_b32 v65, v66
    v_mov_b32 v67, v66
    v_add_f32 v64, v16, v17
    v_add_f32 v66, v18, v19
    v_mov_b32 v16, v64
    v_mov_b32 v17, v66
    s_nop 0
    v_permlane32_swap_b32 v64, v16
    v_permlane32_swap_b32 v66, v17
    v_add_f32 v64, v64, v16
    v_add_f32 v66, v66, v17
    s_lshl_b32 s50, s54, 12
    s_add_u32 s50, s50, 0x17fc000
    s_sub_u32 s51, s32, 8
    s_lshl_b32 s52, s51, 9
    s_add_u32 s52, s52, s50
    s_mov_b32 exec_hi, 0
    buffer_store_dwordx4 v[64:67], v13, s[16:19], s52 offen sc1
    s_mov_b32 exec_hi, -1
    s_mul_i32 s53, s40, 24576
    v_add_u32 v10, s53, v13
    s_lshl_b32 s53, s40, 2
    s_add_u32 s53, s53, 162960
    v_mov_b32 v11, s53
    ds_write_b128 v10, v[80:83] offset:0
    ds_write_b128 v10, v[84:87] offset:1024
    ds_write_b128 v10, v[88:91] offset:2048
    ds_write_b128 v10, v[92:95] offset:3072
    ds_write_b128 v10, v[96:99] offset:4096
    ds_write_b128 v10, v[100:103] offset:5120
    ds_write_b128 v10, v[104:107] offset:6144
    ds_write_b128 v10, v[108:111] offset:7168
    ds_write_b128 v10, v[112:115] offset:8192
    ds_write_b128 v10, v[116:119] offset:9216
    ds_write_b128 v10, v[120:123] offset:10240
    ds_write_b128 v10, v[124:127] offset:11264
    ds_write_b32 v11, v11
    s_mov_b32 s55, 0

MK_B_FIN:

    s_branch MK_ATT
MK_A:
    s_cmp_lg_u32 s33, 0
    s_cbranch_scc1 MK_A_NOTOK

MK_A_TOKP:
    v_mov_b32 v10, 162816
    v_mov_b32 v12, 0
    v_mov_b32 v13, 0
    v_mov_b32 v14, 0
    v_mov_b32 v15, 0
    ds_write_b128 v10, v[12:15]
    ds_write_b128 v10, v[12:15] offset:32
    ds_write_b128 v10, v[12:15] offset:48
    ds_write_b128 v10, v[12:15] offset:64
    ds_write_b128 v10, v[12:15] offset:80
    ds_write_b128 v10, v[12:15] offset:96
    ds_write_b128 v10, v[12:15] offset:112
    ds_write_b128 v10, v[12:15] offset:128
    ds_write_b128 v10, v[12:15] offset:144
    ds_write_b128 v10, v[12:15] offset:160
    ds_write_b128 v10, v[12:15] offset:176
    ds_write_b128 v10, v[12:15] offset:192
    ds_write_b32 v10, v12 offset:16
    ds_write_b32 v10, v12 offset:24
MK_A_NOTOK:
    v_and_b32 v3, 31, v2
    v_lshrrev_b32 v4, 5, v2
    v_bfe_u32 v5, v2, 1, 3
    v_xor_b32 v5, v5, v4
    v_lshlrev_b32 v5, 4, v5
    v_lshl_add_u32 v5, v3, 7, v5
    v_bfe_u32 v6, v2, 2, 2
    v_and_b32 v7, 3, v2
    v_bfe_u32 v14, v2, 4, 1
    v_lshl_add_u32 v15, v4, 3, v6
    s_and_b32 s40, s33, 1
    s_lshr_b32 s41, s33, 1
    s_lshl_b32 s42, s40, 13
    s_lshl_b32 s43, s41, 1
    v_xor_b32 v12, s43, v6
    v_lshlrev_b32 v12, 6, v12
    v_lshl_add_u32 v12, v14, 5, v12
    v_lshl_add_u32 v12, v7, 3, v12
    v_lshl_add_u32 v12, v15, 8, v12
    v_add_u32 v12, 16384, v12
    v_xor_b32 v13, 64, v12
    v_xor_b32 v14, 0, v5
    v_add_u32 v8, s42, v14
    v_xor_b32 v14, 32, v5
    v_add_u32 v9, s42, v14
    v_xor_b32 v14, 64, v5
    v_add_u32 v10, s42, v14
    v_xor_b32 v14, 96, v5
    v_add_u32 v11, s42, v14
    v_mov_b32 v80, 0
    v_mov_b32 v81, 0
    v_mov_b32 v82, 0
    v_mov_b32 v83, 0
    v_mov_b32 v84, 0
    v_mov_b32 v85, 0
    v_mov_b32 v86, 0
    v_mov_b32 v87, 0
    v_mov_b32 v88, 0
    v_mov_b32 v89, 0
    v_mov_b32 v90, 0
    v_mov_b32 v91, 0
    v_mov_b32 v92, 0
    v_mov_b32 v93, 0
    v_mov_b32 v94, 0
    v_mov_b32 v95, 0
    v_mov_b32 v96, 0
    v_mov_b32 v97, 0
    v_mov_b32 v98, 0
    v_mov_b32 v99, 0
    v_mov_b32 v100, 0
    v_mov_b32 v101, 0
    v_mov_b32 v102, 0
    v_mov_b32 v103, 0
    v_mov_b32 v104, 0
    v_mov_b32 v105, 0
    v_mov_b32 v106, 0
    v_mov_b32 v107, 0
    v_mov_b32 v108, 0
    v_mov_b32 v109, 0
    v_mov_b32 v110, 0
    v_mov_b32 v111, 0
    v_mov_b32 v112, 0
    v_mov_b32 v113, 0
    v_mov_b32 v114, 0
    v_mov_b32 v115, 0
    v_mov_b32 v116, 0
    v_mov_b32 v117, 0
    v_mov_b32 v118, 0
    v_mov_b32 v119, 0
    v_mov_b32 v120, 0
    v_mov_b32 v121, 0
    v_mov_b32 v122, 0
    v_mov_b32 v123, 0
    v_mov_b32 v124, 0
    v_mov_b32 v125, 0
    v_mov_b32 v126, 0
    v_mov_b32 v127, 0
    v_mov_b32 v128, 0
    v_mov_b32 v129, 0
    v_mov_b32 v130, 0
    v_mov_b32 v131, 0
    v_mov_b32 v132, 0
    v_mov_b32 v133, 0
    v_mov_b32 v134, 0
    v_mov_b32 v135, 0
    v_mov_b32 v136, 0
    v_mov_b32 v137, 0
    v_mov_b32 v138, 0
    v_mov_b32 v139, 0
    v_mov_b32 v140, 0
    v_mov_b32 v141, 0
    v_mov_b32 v142, 0
    v_mov_b32 v143, 0
    s_cmp_ge_u32 s37, 10
    s_cbranch_scc1 MK_A_V
    s_cmp_ge_u32 s37, 5
    s_cselect_b32 s50, 5, 0
    s_mov_b32 s51, 81920
    s_cselect_b32 s51, 163840, s51
    s_mov_b32 s52, 1280
    s_cselect_b32 s52, 2560, s52
    s_cselect_b32 s53, 0x280000, 0x0
    s_cselect_b32 s54, 1.0, 0x3ea52b5c
    s_sub_u32 s50, s37, s50
    s_lshl_b32 s50, s50, 4
    s_lshl_b32 s55, s41, 3
    s_add_u32 s50, s50, s55
    v_add3_u32 v148, v4, s50, 0
    v_mul_u32_u24 v149, 205, v148
    v_lshrrev_b32 v149, 10, v149
    v_mul_u32_u24 v150, 5, v149
    v_sub_u32 v150, v148, v150
    v_cmp_eq_u32 s[96:97], 2, v150
    v_cmp_lt_u32 vcc, 2, v150
    v_lshlrev_b32 v149, 1, v149
    s_nop 0
    v_addc_co_u32 v149, vcc, 0, v149, vcc
    v_mul_lo_u32 v144, v149, s51
    v_cmp_lt_u32 vcc, 2, v150
    v_subrev_u32 v151, 3, v150
    s_nop 0
    v_cndmask_b32 v150, v150, v151, vcc
    v_lshl_add_u32 v144, v150, 9, v144
    v_lshrrev_b32 v150, 1, v150
    v_sub_u32 v150, 4, v150
    v_lshlrev_b32 v150, v150, v3
    v_add_u32 v144, v144, v150
    s_mov_b64 s[42:43], s[96:97]
    v_add3_u32 v148, v4, s50, 2
    v_mul_u32_u24 v149, 205, v148
    v_lshrrev_b32 v149, 10, v149
    v_mul_u32_u24 v150, 5, v149
    v_sub_u32 v150, v148, v150
    v_cmp_eq_u32 s[96:97], 2, v150
    v_cmp_lt_u32 vcc, 2, v150
    v_lshlrev_b32 v149, 1, v149
    s_nop 0
    v_addc_co_u32 v149, vcc, 0, v149, vcc
    v_mul_lo_u32 v145, v149, s51
    v_cmp_lt_u32 vcc, 2, v150
    v_subrev_u32 v151, 3, v150
    s_nop 0
    v_cndmask_b32 v150, v150, v151, vcc
    v_lshl_add_u32 v145, v150, 9, v145
    v_lshrrev_b32 v150, 1, v150
    v_sub_u32 v150, 4, v150
    v_lshlrev_b32 v150, v150, v3
    v_add_u32 v145, v145, v150
    s_mov_b64 s[44:45], s[96:97]
    v_add3_u32 v148, v4, s50, 4
    v_mul_u32_u24 v149, 205, v148
    v_lshrrev_b32 v149, 10, v149
    v_mul_u32_u24 v150, 5, v149
    v_sub_u32 v150, v148, v150
    v_cmp_eq_u32 s[96:97], 2, v150
    v_cmp_lt_u32 vcc, 2, v150
    v_lshlrev_b32 v149, 1, v149
    s_nop 0
    v_addc_co_u32 v149, vcc, 0, v149, vcc
    v_mul_lo_u32 v146, v149, s51
    v_cmp_lt_u32 vcc, 2, v150
    v_subrev_u32 v151, 3, v150
    s_nop 0
    v_cndmask_b32 v150, v150, v151, vcc
    v_lshl_add_u32 v146, v150, 9, v146
    v_lshrrev_b32 v150, 1, v150
    v_sub_u32 v150, 4, v150
    v_lshlrev_b32 v150, v150, v3
    v_add_u32 v146, v146, v150
    s_mov_b64 s[46:47], s[96:97]
    v_add3_u32 v148, v4, s50, 6
    v_mul_u32_u24 v149, 205, v148
    v_lshrrev_b32 v149, 10, v149
    v_mul_u32_u24 v150, 5, v149
    v_sub_u32 v150, v148, v150
    v_cmp_eq_u32 s[96:97], 2, v150
    v_cmp_lt_u32 vcc, 2, v150
    v_lshlrev_b32 v149, 1, v149
    s_nop 0
    v_addc_co_u32 v149, vcc, 0, v149, vcc
    v_mul_lo_u32 v147, v149, s51
    v_cmp_lt_u32 vcc, 2, v150
    v_subrev_u32 v151, 3, v150
    s_nop 0
    v_cndmask_b32 v150, v150, v151, vcc
    v_lshl_add_u32 v147, v150, 9, v147
    v_lshrrev_b32 v150, 1, v150
    v_sub_u32 v150, 4, v150
    v_lshlrev_b32 v150, v150, v3
    v_add_u32 v147, v147, v150
    s_mov_b64 s[48:49], s[96:97]
    s_lshl_b32 s55, s36, 2
    s_lshl_b32 s56, s40, 1
    s_add_u32 s55, s55, s56
    s_mul_i32 s55, s55, s52
    s_add_u32 s53, s53, s55
    v_lshlrev_b32 v18, 5, v19
    v_lshrrev_b32 v17, 4, v2
    v_lshl_add_u32 v18, v17, 3, v18
    s_lshr_b32 s57, s33, 1
    s_lshl_b32 s57, s57, 4
    s_add_u32 s57, s57, s37
    s_lshl_b32 s57, s57, 4
    s_add_u32 s57, s57, s36
    s_lshl_b32 s57, s57, 1
    s_and_b32 s58, s33, 1
    s_add_u32 s57, s57, s58
    s_lshl_b32 s57, s57, 8
    s_add_u32 s57, s57, 0x17bc000
    s_waitcnt vmcnt(0)
    v_lshlrev_b32 v32, 16, v60
    v_and_b32 v33, 0xffff0000, v60
    v_lshlrev_b32 v34, 16, v61
    v_and_b32 v35, 0xffff0000, v61
    v_lshlrev_b32 v36, 16, v62
    v_and_b32 v37, 0xffff0000, v62
    v_lshlrev_b32 v38, 16, v63
    v_and_b32 v39, 0xffff0000, v63
    v_lshlrev_b32 v40, 16, v64
    v_and_b32 v41, 0xffff0000, v64
    v_lshlrev_b32 v42, 16, v65
    v_and_b32 v43, 0xffff0000, v65
    v_lshlrev_b32 v44, 16, v66
    v_and_b32 v45, 0xffff0000, v66
    v_lshlrev_b32 v46, 16, v67
    v_and_b32 v47, 0xffff0000, v67
    v_pk_add_f32 v[32:33], v[32:33], v[40:41]
    v_pk_add_f32 v[34:35], v[34:35], v[42:43]
    v_pk_add_f32 v[36:37], v[36:37], v[44:45]
    v_pk_add_f32 v[38:39], v[38:39], v[46:47]
    v_lshlrev_b32 v40, 16, v68
    v_and_b32 v41, 0xffff0000, v68
    v_lshlrev_b32 v42, 16, v69
    v_and_b32 v43, 0xffff0000, v69
    v_lshlrev_b32 v44, 16, v70
    v_and_b32 v45, 0xffff0000, v70
    v_lshlrev_b32 v46, 16, v71
    v_and_b32 v47, 0xffff0000, v71
    v_pk_add_f32 v[32:33], v[32:33], v[40:41]
    v_pk_add_f32 v[34:35], v[34:35], v[42:43]
    v_pk_add_f32 v[36:37], v[36:37], v[44:45]
    v_pk_add_f32 v[38:39], v[38:39], v[46:47]
    v_lshlrev_b32 v40, 16, v72
    v_and_b32 v41, 0xffff0000, v72
    v_lshlrev_b32 v42, 16, v73
    v_and_b32 v43, 0xffff0000, v73
    v_lshlrev_b32 v44, 16, v74
    v_and_b32 v45, 0xffff0000, v74
    v_lshlrev_b32 v46, 16, v75
    v_and_b32 v47, 0xffff0000, v75
    v_pk_add_f32 v[32:33], v[32:33], v[40:41]
    v_pk_add_f32 v[34:35], v[34:35], v[42:43]
    v_pk_add_f32 v[36:37], v[36:37], v[44:45]
    v_pk_add_f32 v[38:39], v[38:39], v[46:47]
    v_lshlrev_b32 v40, 16, v76
    v_and_b32 v41, 0xffff0000, v76
    v_lshlrev_b32 v42, 16, v77
    v_and_b32 v43, 0xffff0000, v77
    v_lshlrev_b32 v44, 16, v78
    v_and_b32 v45, 0xffff0000, v78
    v_lshlrev_b32 v46, 16, v79
    v_and_b32 v47, 0xffff0000, v79
    v_pk_add_f32 v[32:33], v[32:33], v[40:41]
    v_pk_add_f32 v[34:35], v[34:35], v[42:43]
    v_pk_add_f32 v[36:37], v[36:37], v[44:45]
    v_pk_add_f32 v[38:39], v[38:39], v[46:47]
    s_nop 0
    v_permlane32_swap_b32 v32, v36
    v_permlane32_swap_b32 v33, v37
    v_permlane32_swap_b32 v34, v38
    v_permlane32_swap_b32 v35, v39
    v_add_f32 v32, v32, v36
    v_add_f32 v33, v33, v37
    v_add_f32 v34, v34, v38
    v_add_f32 v35, v35, v39
    s_nop 0
    v_permlane16_swap_b32 v32, v34
    v_permlane16_swap_b32 v33, v35
    v_add_f32 v32, v32, v34
    v_add_f32 v33, v33, v35
    s_nop 0
    v_add_f32_dpp v32, v32, v32 row_ror:8 row_mask:0xf bank_mask:0xf
    v_add_f32_dpp v33, v33, v33 row_ror:8 row_mask:0xf bank_mask:0xf
    buffer_store_dwordx2 v[32:33], v18, s[16:19], s57 offen sc1
    s_waitcnt lgkmcnt(0)

    s_setprio 0
    s_barrier

    s_mov_b32 s60, 0
    s_mov_b32 s61, 10
    ds_read_b128 v[16:19], v8 offset:0
    ds_read_b64_tr_b16 v[32:33], v12 offset:0
    ds_read_b64_tr_b16 v[34:35], v12 offset:1024
    ds_read_b128 v[20:23], v8 offset:4096
    ds_read_b64_tr_b16 v[36:37], v13 offset:0
    ds_read_b64_tr_b16 v[38:39], v13 offset:1024
    ds_read_b128 v[24:27], v9 offset:0
    ds_read_b64_tr_b16 v[40:41], v12 offset:4096
    ds_read_b64_tr_b16 v[42:43], v12 offset:5120
    ds_read_b128 v[28:31], v9 offset:4096
    ds_read_b64_tr_b16 v[44:45], v13 offset:4096
    ds_read_b64_tr_b16 v[46:47], v13 offset:5120
.p2align 4
MK_AL_QK:
    s_waitcnt lgkmcnt(0)
    v_mfma_f32_32x32x16_bf16 v[80:95], v[32:35], v[16:19], v[80:95]
    ds_read_b128 v[48:51], v10 offset:0
    ds_read_b64_tr_b16 v[64:65], v12 offset:8192
    v_mfma_f32_32x32x16_bf16 v[112:127], v[32:35], v[20:23], v[112:127]
    ds_read_b64_tr_b16 v[66:67], v12 offset:9216
    v_mfma_f32_32x32x16_bf16 v[96:111], v[36:39], v[16:19], v[96:111]
    ds_read_b128 v[52:55], v10 offset:4096
    ds_read_b64_tr_b16 v[68:69], v13 offset:8192
    v_mfma_f32_32x32x16_bf16 v[128:143], v[36:39], v[20:23], v[128:143]
    ds_read_b64_tr_b16 v[70:71], v13 offset:9216
    v_mfma_f32_32x32x16_bf16 v[80:95], v[40:43], v[24:27], v[80:95]
    ds_read_b128 v[56:59], v11 offset:0
    ds_read_b64_tr_b16 v[72:73], v12 offset:12288
    v_mfma_f32_32x32x16_bf16 v[112:127], v[40:43], v[28:31], v[112:127]
    ds_read_b64_tr_b16 v[74:75], v12 offset:13312
    v_mfma_f32_32x32x16_bf16 v[96:111], v[44:47], v[24:27], v[96:111]
    ds_read_b128 v[60:63], v11 offset:4096
    ds_read_b64_tr_b16 v[76:77], v13 offset:12288
    v_mfma_f32_32x32x16_bf16 v[128:143], v[44:47], v[28:31], v[128:143]
    ds_read_b64_tr_b16 v[78:79], v13 offset:13312
    s_add_u32 s60, s60, 1
    s_cmp_eq_u32 s60, 3
    s_mov_b32 s62, 45056
    s_cselect_b32 s62, 0xfffea000, s62
    s_cselect_b32 s60, 0, s60
    v_add_u32 v8, s62, v8
    v_add_u32 v9, s62, v9
    v_add_u32 v10, s62, v10
    v_add_u32 v11, s62, v11
    v_add_u32 v12, s62, v12
    v_add_u32 v13, s62, v13
    s_cmp_lg_u32 s61, 9
    s_cbranch_scc1 MK_AL_QK_NH
    s_waitcnt vmcnt(0)

MK_AL_QK_NH:
    s_waitcnt lgkmcnt(0)
    s_barrier
    v_mfma_f32_32x32x16_bf16 v[80:95], v[64:67], v[48:51], v[80:95]
    ds_read_b128 v[16:19], v8 offset:0
    ds_read_b64_tr_b16 v[32:33], v12 offset:0
    v_mfma_f32_32x32x16_bf16 v[112:127], v[64:67], v[52:55], v[112:127]
    ds_read_b64_tr_b16 v[34:35], v12 offset:1024
    v_mfma_f32_32x32x16_bf16 v[96:111], v[68:71], v[48:51], v[96:111]
    ds_read_b128 v[20:23], v8 offset:4096
    ds_read_b64_tr_b16 v[36:37], v13 offset:0
    v_mfma_f32_32x32x16_bf16 v[128:143], v[68:71], v[52:55], v[128:143]
    ds_read_b64_tr_b16 v[38:39], v13 offset:1024
    v_mfma_f32_32x32x16_bf16 v[80:95], v[72:75], v[56:59], v[80:95]
    ds_read_b128 v[24:27], v9 offset:0
    ds_read_b64_tr_b16 v[40:41], v12 offset:4096
    v_mfma_f32_32x32x16_bf16 v[112:127], v[72:75], v[60:63], v[112:127]
    ds_read_b64_tr_b16 v[42:43], v12 offset:5120
    v_mfma_f32_32x32x16_bf16 v[96:111], v[76:79], v[56:59], v[96:111]
    ds_read_b128 v[28:31], v9 offset:4096
    ds_read_b64_tr_b16 v[44:45], v13 offset:4096
    v_mfma_f32_32x32x16_bf16 v[128:143], v[76:79], v[60:63], v[128:143]
    ds_read_b64_tr_b16 v[46:47], v13 offset:5120
    s_sub_u32 s61, s61, 1
    s_cmp_lg_u32 s61, 0
    s_cbranch_scc1 MK_AL_QK
    s_waitcnt lgkmcnt(0)
    s_setprio 2

    v_lshlrev_b32 v148, 4, v4
    v_lshlrev_b32 v149, 2, v3
    s_lshl_b32 s55, s40, 8
    s_add_u32 s55, s55, 136192
    v_add_u32 v149, s55, v149
    ds_read_b32 v8, v149
    ds_read_b32 v9, v149 offset:512
    ds_read_b32 v10, v149 offset:128
    ds_read_b32 v11, v149 offset:640
    s_lshl_b32 s55, s41, 8
    s_add_u32 s55, s55, 137216
    v_add_u32 v148, s55, v148
    ds_read_b128 v[16:19], v148 offset:0
    ds_read_b128 v[20:23], v148 offset:32
    ds_read_b128 v[24:27], v148 offset:64
    ds_read_b128 v[28:31], v148 offset:96
    ds_read_b128 v[32:35], v148 offset:128
    ds_read_b128 v[36:39], v148 offset:160
    ds_read_b128 v[40:43], v148 offset:192
    ds_read_b128 v[44:47], v148 offset:224
    s_waitcnt lgkmcnt(0)
    v_mul_f32 v9, s54, v9
    v_mul_f32 v11, s54, v11
    v_pk_fma_f32 v[80:81], v[16:17], v[8:9], v[80:81] op_sel_hi:[1,0,1]
    v_pk_fma_f32 v[82:83], v[18:19], v[8:9], v[82:83] op_sel_hi:[1,0,1]
    v_pk_fma_f32 v[84:85], v[20:21], v[8:9], v[84:85] op_sel_hi:[1,0,1]
    v_pk_fma_f32 v[86:87], v[22:23], v[8:9], v[86:87] op_sel_hi:[1,0,1]
    v_pk_fma_f32 v[88:89], v[24:25], v[8:9], v[88:89] op_sel_hi:[1,0,1]
    v_pk_fma_f32 v[90:91], v[26:27], v[8:9], v[90:91] op_sel_hi:[1,0,1]
    v_pk_fma_f32 v[92:93], v[28:29], v[8:9], v[92:93] op_sel_hi:[1,0,1]
    v_pk_fma_f32 v[94:95], v[30:31], v[8:9], v[94:95] op_sel_hi:[1,0,1]
    v_pk_mul_f32 v[80:81], v[80:81], v[8:9] op_sel:[0,1]
    v_pk_mul_f32 v[82:83], v[82:83], v[8:9] op_sel:[0,1]
    v_pk_mul_f32 v[84:85], v[84:85], v[8:9] op_sel:[0,1]
    v_pk_mul_f32 v[86:87], v[86:87], v[8:9] op_sel:[0,1]
    v_pk_mul_f32 v[88:89], v[88:89], v[8:9] op_sel:[0,1]
    v_pk_mul_f32 v[90:91], v[90:91], v[8:9] op_sel:[0,1]
    v_pk_mul_f32 v[92:93], v[92:93], v[8:9] op_sel:[0,1]
    v_pk_mul_f32 v[94:95], v[94:95], v[8:9] op_sel:[0,1]
    v_cvt_pk_bf16_f32 v80, v80, v81
    v_cvt_pk_bf16_f32 v81, v82, v83
    v_cvt_pk_bf16_f32 v82, v84, v85
    v_cvt_pk_bf16_f32 v83, v86, v87
    v_cvt_pk_bf16_f32 v84, v88, v89
    v_cvt_pk_bf16_f32 v85, v90, v91
    v_cvt_pk_bf16_f32 v86, v92, v93
    v_cvt_pk_bf16_f32 v87, v94, v95
    v_permlane32_swap_b32 v80, v82
    v_permlane32_swap_b32 v81, v83
    v_permlane32_swap_b32 v84, v86
    v_permlane32_swap_b32 v85, v87
    s_add_u32 s56, s53, s51
    s_not_b64 exec, s[42:43]
    buffer_store_dwordx4 v[80:83], v144, s[16:19], s53 offen sc1
    s_mov_b64 exec, s[42:43]
    s_cbranch_execz MK_A_T00
    buffer_store_dwordx2 v[80:81], v144, s[16:19], s53 offen sc1
    buffer_store_dwordx2 v[82:83], v144, s[16:19], s56 offen sc1
MK_A_T00:
    s_mov_b64 exec, -1
    s_not_b64 exec, s[44:45]
    buffer_store_dwordx4 v[84:87], v145, s[16:19], s53 offen sc1
    s_mov_b64 exec, s[44:45]
    s_cbranch_execz MK_A_T01
    buffer_store_dwordx2 v[84:85], v145, s[16:19], s53 offen sc1
    buffer_store_dwordx2 v[86:87], v145, s[16:19], s56 offen sc1
MK_A_T01:
    s_mov_b64 exec, -1
    v_pk_fma_f32 v[96:97], v[32:33], v[8:9], v[96:97] op_sel_hi:[1,0,1]
    v_pk_fma_f32 v[98:99], v[34:35], v[8:9], v[98:99] op_sel_hi:[1,0,1]
    v_pk_fma_f32 v[100:101], v[36:37], v[8:9], v[100:101] op_sel_hi:[1,0,1]
    v_pk_fma_f32 v[102:103], v[38:39], v[8:9], v[102:103] op_sel_hi:[1,0,1]
    v_pk_fma_f32 v[104:105], v[40:41], v[8:9], v[104:105] op_sel_hi:[1,0,1]
    v_pk_fma_f32 v[106:107], v[42:43], v[8:9], v[106:107] op_sel_hi:[1,0,1]
    v_pk_fma_f32 v[108:109], v[44:45], v[8:9], v[108:109] op_sel_hi:[1,0,1]
    v_pk_fma_f32 v[110:111], v[46:47], v[8:9], v[110:111] op_sel_hi:[1,0,1]
    v_pk_mul_f32 v[96:97], v[96:97], v[8:9] op_sel:[0,1]
    v_pk_mul_f32 v[98:99], v[98:99], v[8:9] op_sel:[0,1]
    v_pk_mul_f32 v[100:101], v[100:101], v[8:9] op_sel:[0,1]
    v_pk_mul_f32 v[102:103], v[102:103], v[8:9] op_sel:[0,1]
    v_pk_mul_f32 v[104:105], v[104:105], v[8:9] op_sel:[0,1]
    v_pk_mul_f32 v[106:107], v[106:107], v[8:9] op_sel:[0,1]
    v_pk_mul_f32 v[108:109], v[108:109], v[8:9] op_sel:[0,1]
    v_pk_mul_f32 v[110:111], v[110:111], v[8:9] op_sel:[0,1]
    v_cvt_pk_bf16_f32 v96, v96, v97
    v_cvt_pk_bf16_f32 v97, v98, v99
    v_cvt_pk_bf16_f32 v98, v100, v101
    v_cvt_pk_bf16_f32 v99, v102, v103
    v_cvt_pk_bf16_f32 v100, v104, v105
    v_cvt_pk_bf16_f32 v101, v106, v107
    v_cvt_pk_bf16_f32 v102, v108, v109
    v_cvt_pk_bf16_f32 v103, v110, v111
    v_permlane32_swap_b32 v96, v98
    v_permlane32_swap_b32 v97, v99
    v_permlane32_swap_b32 v100, v102
    v_permlane32_swap_b32 v101, v103
    s_add_u32 s56, s53, s51
    s_not_b64 exec, s[46:47]
    buffer_store_dwordx4 v[96:99], v146, s[16:19], s53 offen sc1
    s_mov_b64 exec, s[46:47]
    s_cbranch_execz MK_A_T02
    buffer_store_dwordx2 v[96:97], v146, s[16:19], s53 offen sc1
    buffer_store_dwordx2 v[98:99], v146, s[16:19], s56 offen sc1
MK_A_T02:
    s_mov_b64 exec, -1
    s_not_b64 exec, s[48:49]
    buffer_store_dwordx4 v[100:103], v147, s[16:19], s53 offen sc1
    s_mov_b64 exec, s[48:49]
    s_cbranch_execz MK_A_T03
    buffer_store_dwordx2 v[100:101], v147, s[16:19], s53 offen sc1
    buffer_store_dwordx2 v[102:103], v147, s[16:19], s56 offen sc1
MK_A_T03:
    s_mov_b64 exec, -1
    s_add_u32 s53, s53, s52
    v_pk_fma_f32 v[112:113], v[16:17], v[10:11], v[112:113] op_sel_hi:[1,0,1]
    v_pk_fma_f32 v[114:115], v[18:19], v[10:11], v[114:115] op_sel_hi:[1,0,1]
    v_pk_fma_f32 v[116:117], v[20:21], v[10:11], v[116:117] op_sel_hi:[1,0,1]
    v_pk_fma_f32 v[118:119], v[22:23], v[10:11], v[118:119] op_sel_hi:[1,0,1]
    v_pk_fma_f32 v[120:121], v[24:25], v[10:11], v[120:121] op_sel_hi:[1,0,1]
    v_pk_fma_f32 v[122:123], v[26:27], v[10:11], v[122:123] op_sel_hi:[1,0,1]
    v_pk_fma_f32 v[124:125], v[28:29], v[10:11], v[124:125] op_sel_hi:[1,0,1]
    v_pk_fma_f32 v[126:127], v[30:31], v[10:11], v[126:127] op_sel_hi:[1,0,1]
    v_pk_mul_f32 v[112:113], v[112:113], v[10:11] op_sel:[0,1]
    v_pk_mul_f32 v[114:115], v[114:115], v[10:11] op_sel:[0,1]
    v_pk_mul_f32 v[116:117], v[116:117], v[10:11] op_sel:[0,1]
    v_pk_mul_f32 v[118:119], v[118:119], v[10:11] op_sel:[0,1]
    v_pk_mul_f32 v[120:121], v[120:121], v[10:11] op_sel:[0,1]
    v_pk_mul_f32 v[122:123], v[122:123], v[10:11] op_sel:[0,1]
    v_pk_mul_f32 v[124:125], v[124:125], v[10:11] op_sel:[0,1]
    v_pk_mul_f32 v[126:127], v[126:127], v[10:11] op_sel:[0,1]
    v_cvt_pk_bf16_f32 v112, v112, v113
    v_cvt_pk_bf16_f32 v113, v114, v115
    v_cvt_pk_bf16_f32 v114, v116, v117
    v_cvt_pk_bf16_f32 v115, v118, v119
    v_cvt_pk_bf16_f32 v116, v120, v121
    v_cvt_pk_bf16_f32 v117, v122, v123
    v_cvt_pk_bf16_f32 v118, v124, v125
    v_cvt_pk_bf16_f32 v119, v126, v127
    v_permlane32_swap_b32 v112, v114
    v_permlane32_swap_b32 v113, v115
    v_permlane32_swap_b32 v116, v118
    v_permlane32_swap_b32 v117, v119
    s_add_u32 s56, s53, s51
    s_not_b64 exec, s[42:43]
    buffer_store_dwordx4 v[112:115], v144, s[16:19], s53 offen sc1
    s_mov_b64 exec, s[42:43]
    s_cbranch_execz MK_A_T10
    buffer_store_dwordx2 v[112:113], v144, s[16:19], s53 offen sc1
    buffer_store_dwordx2 v[114:115], v144, s[16:19], s56 offen sc1
MK_A_T10:
    s_mov_b64 exec, -1
    s_not_b64 exec, s[44:45]
    buffer_store_dwordx4 v[116:119], v145, s[16:19], s53 offen sc1
    s_mov_b64 exec, s[44:45]
    s_cbranch_execz MK_A_T11
    buffer_store_dwordx2 v[116:117], v145, s[16:19], s53 offen sc1
    buffer_store_dwordx2 v[118:119], v145, s[16:19], s56 offen sc1
MK_A_T11:
    s_mov_b64 exec, -1
    v_pk_fma_f32 v[128:129], v[32:33], v[10:11], v[128:129] op_sel_hi:[1,0,1]
    v_pk_fma_f32 v[130:131], v[34:35], v[10:11], v[130:131] op_sel_hi:[1,0,1]
    v_pk_fma_f32 v[132:133], v[36:37], v[10:11], v[132:133] op_sel_hi:[1,0,1]
    v_pk_fma_f32 v[134:135], v[38:39], v[10:11], v[134:135] op_sel_hi:[1,0,1]
    v_pk_fma_f32 v[136:137], v[40:41], v[10:11], v[136:137] op_sel_hi:[1,0,1]
    v_pk_fma_f32 v[138:139], v[42:43], v[10:11], v[138:139] op_sel_hi:[1,0,1]
    v_pk_fma_f32 v[140:141], v[44:45], v[10:11], v[140:141] op_sel_hi:[1,0,1]
    v_pk_fma_f32 v[142:143], v[46:47], v[10:11], v[142:143] op_sel_hi:[1,0,1]
    v_pk_mul_f32 v[128:129], v[128:129], v[10:11] op_sel:[0,1]
    v_pk_mul_f32 v[130:131], v[130:131], v[10:11] op_sel:[0,1]
    v_pk_mul_f32 v[132:133], v[132:133], v[10:11] op_sel:[0,1]
    v_pk_mul_f32 v[134:135], v[134:135], v[10:11] op_sel:[0,1]
    v_pk_mul_f32 v[136:137], v[136:137], v[10:11] op_sel:[0,1]
    v_pk_mul_f32 v[138:139], v[138:139], v[10:11] op_sel:[0,1]
    v_pk_mul_f32 v[140:141], v[140:141], v[10:11] op_sel:[0,1]
    v_pk_mul_f32 v[142:143], v[142:143], v[10:11] op_sel:[0,1]
    v_cvt_pk_bf16_f32 v128, v128, v129
    v_cvt_pk_bf16_f32 v129, v130, v131
    v_cvt_pk_bf16_f32 v130, v132, v133
    v_cvt_pk_bf16_f32 v131, v134, v135
    v_cvt_pk_bf16_f32 v132, v136, v137
    v_cvt_pk_bf16_f32 v133, v138, v139
    v_cvt_pk_bf16_f32 v134, v140, v141
    v_cvt_pk_bf16_f32 v135, v142, v143
    v_permlane32_swap_b32 v128, v130
    v_permlane32_swap_b32 v129, v131
    v_permlane32_swap_b32 v132, v134
    v_permlane32_swap_b32 v133, v135
    s_add_u32 s56, s53, s51
    s_not_b64 exec, s[46:47]
    buffer_store_dwordx4 v[128:131], v146, s[16:19], s53 offen sc1
    s_mov_b64 exec, s[46:47]
    s_cbranch_execz MK_A_T12
    buffer_store_dwordx2 v[128:129], v146, s[16:19], s53 offen sc1
    buffer_store_dwordx2 v[130:131], v146, s[16:19], s56 offen sc1
MK_A_T12:
    s_mov_b64 exec, -1
    s_not_b64 exec, s[48:49]
    buffer_store_dwordx4 v[132:135], v147, s[16:19], s53 offen sc1
    s_mov_b64 exec, s[48:49]
    s_cbranch_execz MK_A_T13
    buffer_store_dwordx2 v[132:133], v147, s[16:19], s53 offen sc1
    buffer_store_dwordx2 v[134:135], v147, s[16:19], s56 offen sc1
MK_A_T13:
    s_mov_b64 exec, -1
    s_add_u32 s53, s53, s52
    s_branch MK_A_FIN
MK_A_V:
    s_sub_u32 s50, s37, 10
    s_lshl_b32 s50, s50, 7
    s_lshl_b32 s55, s41, 6
    s_add_u32 s50, s50, s55
    s_mov_b32 s51, 163840
    s_mov_b32 s52, 2560
    s_mov_b32 s53, 0x280500
    v_add3_u32 v148, v3, s50, 0
    v_mul_u32_u24 v149, 3277, v148
    v_lshrrev_b32 v149, 16, v149
    v_mul_u32_u24 v150, 20, v149
    v_sub_u32 v150, v148, v150
    v_mul_lo_u32 v144, v149, s51
    v_mad_u32_u24 v150, v4, 20, v150
    v_lshl_add_u32 v144, v150, 4, v144
    v_add3_u32 v148, v3, s50, 32
    v_mul_u32_u24 v149, 3277, v148
    v_lshrrev_b32 v149, 16, v149
    v_mul_u32_u24 v150, 20, v149
    v_sub_u32 v150, v148, v150
    v_mul_lo_u32 v145, v149, s51
    v_mad_u32_u24 v150, v4, 20, v150
    v_lshl_add_u32 v145, v150, 4, v145
    s_lshl_b32 s55, s36, 2
    s_lshl_b32 s56, s40, 1
    s_add_u32 s55, s55, s56
    s_mul_i32 s55, s55, s52
    s_add_u32 s53, s53, s55
    v_lshlrev_b32 v18, 5, v19
    v_lshrrev_b32 v17, 4, v2
    v_lshl_add_u32 v18, v17, 3, v18
    s_lshr_b32 s57, s33, 1
    s_lshl_b32 s57, s57, 4
    s_add_u32 s57, s57, s37
    s_lshl_b32 s57, s57, 4
    s_add_u32 s57, s57, s36
    s_lshl_b32 s57, s57, 1
    s_and_b32 s58, s33, 1
    s_add_u32 s57, s57, s58
    s_lshl_b32 s57, s57, 8
    s_add_u32 s57, s57, 0x17bc000
    s_waitcnt vmcnt(0)
    v_lshlrev_b32 v32, 16, v60
    v_and_b32 v33, 0xffff0000, v60
    v_lshlrev_b32 v34, 16, v61
    v_and_b32 v35, 0xffff0000, v61
    v_lshlrev_b32 v36, 16, v62
    v_and_b32 v37, 0xffff0000, v62
    v_lshlrev_b32 v38, 16, v63
    v_and_b32 v39, 0xffff0000, v63
    v_lshlrev_b32 v40, 16, v64
    v_and_b32 v41, 0xffff0000, v64
    v_lshlrev_b32 v42, 16, v65
    v_and_b32 v43, 0xffff0000, v65
    v_lshlrev_b32 v44, 16, v66
    v_and_b32 v45, 0xffff0000, v66
    v_lshlrev_b32 v46, 16, v67
    v_and_b32 v47, 0xffff0000, v67
    v_pk_add_f32 v[32:33], v[32:33], v[40:41]
    v_pk_add_f32 v[34:35], v[34:35], v[42:43]
    v_pk_add_f32 v[36:37], v[36:37], v[44:45]
    v_pk_add_f32 v[38:39], v[38:39], v[46:47]
    v_lshlrev_b32 v40, 16, v68
    v_and_b32 v41, 0xffff0000, v68
    v_lshlrev_b32 v42, 16, v69
    v_and_b32 v43, 0xffff0000, v69
    v_lshlrev_b32 v44, 16, v70
    v_and_b32 v45, 0xffff0000, v70
    v_lshlrev_b32 v46, 16, v71
    v_and_b32 v47, 0xffff0000, v71
    v_pk_add_f32 v[32:33], v[32:33], v[40:41]
    v_pk_add_f32 v[34:35], v[34:35], v[42:43]
    v_pk_add_f32 v[36:37], v[36:37], v[44:45]
    v_pk_add_f32 v[38:39], v[38:39], v[46:47]
    v_lshlrev_b32 v40, 16, v72
    v_and_b32 v41, 0xffff0000, v72
    v_lshlrev_b32 v42, 16, v73
    v_and_b32 v43, 0xffff0000, v73
    v_lshlrev_b32 v44, 16, v74
    v_and_b32 v45, 0xffff0000, v74
    v_lshlrev_b32 v46, 16, v75
    v_and_b32 v47, 0xffff0000, v75
    v_pk_add_f32 v[32:33], v[32:33], v[40:41]
    v_pk_add_f32 v[34:35], v[34:35], v[42:43]
    v_pk_add_f32 v[36:37], v[36:37], v[44:45]
    v_pk_add_f32 v[38:39], v[38:39], v[46:47]
    v_lshlrev_b32 v40, 16, v76
    v_and_b32 v41, 0xffff0000, v76
    v_lshlrev_b32 v42, 16, v77
    v_and_b32 v43, 0xffff0000, v77
    v_lshlrev_b32 v44, 16, v78
    v_and_b32 v45, 0xffff0000, v78
    v_lshlrev_b32 v46, 16, v79
    v_and_b32 v47, 0xffff0000, v79
    v_pk_add_f32 v[32:33], v[32:33], v[40:41]
    v_pk_add_f32 v[34:35], v[34:35], v[42:43]
    v_pk_add_f32 v[36:37], v[36:37], v[44:45]
    v_pk_add_f32 v[38:39], v[38:39], v[46:47]
    s_nop 0
    v_permlane32_swap_b32 v32, v36
    v_permlane32_swap_b32 v33, v37
    v_permlane32_swap_b32 v34, v38
    v_permlane32_swap_b32 v35, v39
    v_add_f32 v32, v32, v36
    v_add_f32 v33, v33, v37
    v_add_f32 v34, v34, v38
    v_add_f32 v35, v35, v39
    s_nop 0
    v_permlane16_swap_b32 v32, v34
    v_permlane16_swap_b32 v33, v35
    v_add_f32 v32, v32, v34
    v_add_f32 v33, v33, v35
    s_nop 0
    v_add_f32_dpp v32, v32, v32 row_ror:8 row_mask:0xf bank_mask:0xf
    v_add_f32_dpp v33, v33, v33 row_ror:8 row_mask:0xf bank_mask:0xf
    buffer_store_dwordx2 v[32:33], v18, s[16:19], s57 offen sc1
    s_waitcnt lgkmcnt(0)

    s_setprio 0
    s_barrier

    s_mov_b32 s60, 0
    s_mov_b32 s61, 10
    ds_read_b128 v[16:19], v8 offset:0
    ds_read_b64_tr_b16 v[32:33], v12 offset:0
    ds_read_b64_tr_b16 v[34:35], v12 offset:1024
    ds_read_b128 v[20:23], v8 offset:4096
    ds_read_b64_tr_b16 v[36:37], v13 offset:0
    ds_read_b64_tr_b16 v[38:39], v13 offset:1024
    ds_read_b128 v[24:27], v9 offset:0
    ds_read_b64_tr_b16 v[40:41], v12 offset:4096
    ds_read_b64_tr_b16 v[42:43], v12 offset:5120
    ds_read_b128 v[28:31], v9 offset:4096
    ds_read_b64_tr_b16 v[44:45], v13 offset:4096
    ds_read_b64_tr_b16 v[46:47], v13 offset:5120
.p2align 4
MK_AL_V:
    s_waitcnt lgkmcnt(0)
    v_mfma_f32_32x32x16_bf16 v[80:95], v[16:19], v[32:35], v[80:95]
    ds_read_b128 v[48:51], v10 offset:0
    ds_read_b64_tr_b16 v[64:65], v12 offset:8192
    v_mfma_f32_32x32x16_bf16 v[112:127], v[20:23], v[32:35], v[112:127]
    ds_read_b64_tr_b16 v[66:67], v12 offset:9216
    v_mfma_f32_32x32x16_bf16 v[96:111], v[16:19], v[36:39], v[96:111]
    ds_read_b128 v[52:55], v10 offset:4096
    ds_read_b64_tr_b16 v[68:69], v13 offset:8192
    v_mfma_f32_32x32x16_bf16 v[128:143], v[20:23], v[36:39], v[128:143]
    ds_read_b64_tr_b16 v[70:71], v13 offset:9216
    v_mfma_f32_32x32x16_bf16 v[80:95], v[24:27], v[40:43], v[80:95]
    ds_read_b128 v[56:59], v11 offset:0
    ds_read_b64_tr_b16 v[72:73], v12 offset:12288
    v_mfma_f32_32x32x16_bf16 v[112:127], v[28:31], v[40:43], v[112:127]
    ds_read_b64_tr_b16 v[74:75], v12 offset:13312
    v_mfma_f32_32x32x16_bf16 v[96:111], v[24:27], v[44:47], v[96:111]
    ds_read_b128 v[60:63], v11 offset:4096
    ds_read_b64_tr_b16 v[76:77], v13 offset:12288
    v_mfma_f32_32x32x16_bf16 v[128:143], v[28:31], v[44:47], v[128:143]
    ds_read_b64_tr_b16 v[78:79], v13 offset:13312
    s_add_u32 s60, s60, 1
    s_cmp_eq_u32 s60, 3
    s_mov_b32 s62, 45056
    s_cselect_b32 s62, 0xfffea000, s62
    s_cselect_b32 s60, 0, s60
    v_add_u32 v8, s62, v8
    v_add_u32 v9, s62, v9
    v_add_u32 v10, s62, v10
    v_add_u32 v11, s62, v11
    v_add_u32 v12, s62, v12
    v_add_u32 v13, s62, v13
    s_cmp_lg_u32 s61, 9
    s_cbranch_scc1 MK_AL_V_NH
    s_waitcnt vmcnt(0)

MK_AL_V_NH:
    s_waitcnt lgkmcnt(0)
    s_barrier
    v_mfma_f32_32x32x16_bf16 v[80:95], v[48:51], v[64:67], v[80:95]
    ds_read_b128 v[16:19], v8 offset:0
    ds_read_b64_tr_b16 v[32:33], v12 offset:0
    v_mfma_f32_32x32x16_bf16 v[112:127], v[52:55], v[64:67], v[112:127]
    ds_read_b64_tr_b16 v[34:35], v12 offset:1024
    v_mfma_f32_32x32x16_bf16 v[96:111], v[48:51], v[68:71], v[96:111]
    ds_read_b128 v[20:23], v8 offset:4096
    ds_read_b64_tr_b16 v[36:37], v13 offset:0
    v_mfma_f32_32x32x16_bf16 v[128:143], v[52:55], v[68:71], v[128:143]
    ds_read_b64_tr_b16 v[38:39], v13 offset:1024
    v_mfma_f32_32x32x16_bf16 v[80:95], v[56:59], v[72:75], v[80:95]
    ds_read_b128 v[24:27], v9 offset:0
    ds_read_b64_tr_b16 v[40:41], v12 offset:4096
    v_mfma_f32_32x32x16_bf16 v[112:127], v[60:63], v[72:75], v[112:127]
    ds_read_b64_tr_b16 v[42:43], v12 offset:5120
    v_mfma_f32_32x32x16_bf16 v[96:111], v[56:59], v[76:79], v[96:111]
    ds_read_b128 v[28:31], v9 offset:4096
    ds_read_b64_tr_b16 v[44:45], v13 offset:4096
    v_mfma_f32_32x32x16_bf16 v[128:143], v[60:63], v[76:79], v[128:143]
    ds_read_b64_tr_b16 v[46:47], v13 offset:5120
    s_sub_u32 s61, s61, 1
    s_cmp_lg_u32 s61, 0
    s_cbranch_scc1 MK_AL_V
    s_waitcnt lgkmcnt(0)
    s_setprio 2

    v_lshlrev_b32 v148, 4, v4
    v_lshlrev_b32 v149, 2, v3
    s_lshl_b32 s55, s41, 8
    s_add_u32 s55, s55, 137216
    v_add_u32 v149, s55, v149
    ds_read_b32 v8, v149
    ds_read_b32 v9, v149 offset:128
    s_lshl_b32 s55, s40, 8
    s_add_u32 s55, s55, 136192
    v_add_u32 v148, s55, v148
    ds_read_b128 v[16:19], v148 offset:0
    ds_read_b128 v[20:23], v148 offset:32
    ds_read_b128 v[24:27], v148 offset:64
    ds_read_b128 v[28:31], v148 offset:96
    ds_read_b128 v[32:35], v148 offset:128
    ds_read_b128 v[36:39], v148 offset:160
    ds_read_b128 v[40:43], v148 offset:192
    ds_read_b128 v[44:47], v148 offset:224
    s_waitcnt lgkmcnt(4)
    ds_read_b128 v[48:51], v148 offset:512
    ds_read_b128 v[52:55], v148 offset:544
    ds_read_b128 v[56:59], v148 offset:576
    ds_read_b128 v[60:63], v148 offset:608
    ds_read_b128 v[64:67], v148 offset:640
    ds_read_b128 v[68:71], v148 offset:672
    ds_read_b128 v[72:75], v148 offset:704
    ds_read_b128 v[76:79], v148 offset:736
    s_waitcnt lgkmcnt(0)
    s_cmp_eq_u32 s37, 15
    s_cbranch_scc1 MK_A_SKIP
    v_pk_fma_f32 v[80:81], v[16:17], v[8:9], v[80:81] op_sel:[0,0,0] op_sel_hi:[1,0,1]
    v_pk_fma_f32 v[82:83], v[18:19], v[8:9], v[82:83] op_sel:[0,0,0] op_sel_hi:[1,0,1]
    v_pk_fma_f32 v[84:85], v[20:21], v[8:9], v[84:85] op_sel:[0,0,0] op_sel_hi:[1,0,1]
    v_pk_fma_f32 v[86:87], v[22:23], v[8:9], v[86:87] op_sel:[0,0,0] op_sel_hi:[1,0,1]
    v_pk_fma_f32 v[88:89], v[24:25], v[8:9], v[88:89] op_sel:[0,0,0] op_sel_hi:[1,0,1]
    v_pk_fma_f32 v[90:91], v[26:27], v[8:9], v[90:91] op_sel:[0,0,0] op_sel_hi:[1,0,1]
    v_pk_fma_f32 v[92:93], v[28:29], v[8:9], v[92:93] op_sel:[0,0,0] op_sel_hi:[1,0,1]
    v_pk_fma_f32 v[94:95], v[30:31], v[8:9], v[94:95] op_sel:[0,0,0] op_sel_hi:[1,0,1]
    v_pk_mul_f32 v[80:81], v[80:81], v[48:49]
    v_pk_mul_f32 v[82:83], v[82:83], v[50:51]
    v_pk_mul_f32 v[84:85], v[84:85], v[52:53]
    v_pk_mul_f32 v[86:87], v[86:87], v[54:55]
    v_pk_mul_f32 v[88:89], v[88:89], v[56:57]
    v_pk_mul_f32 v[90:91], v[90:91], v[58:59]
    v_pk_mul_f32 v[92:93], v[92:93], v[60:61]
    v_pk_mul_f32 v[94:95], v[94:95], v[62:63]
    v_cvt_pk_bf16_f32 v80, v80, v81
    v_cvt_pk_bf16_f32 v81, v82, v83
    v_cvt_pk_bf16_f32 v82, v84, v85
    v_cvt_pk_bf16_f32 v83, v86, v87
    v_cvt_pk_bf16_f32 v84, v88, v89
    v_cvt_pk_bf16_f32 v85, v90, v91
    v_cvt_pk_bf16_f32 v86, v92, v93
    v_cvt_pk_bf16_f32 v87, v94, v95
    buffer_store_dwordx4 v[80:83], v144, s[16:19], s53 offen sc1
    buffer_store_dwordx4 v[84:87], v144, s[16:19], s53 offen offset:640 sc1
    v_pk_fma_f32 v[96:97], v[16:17], v[8:9], v[96:97] op_sel:[0,1,0] op_sel_hi:[1,1,1]
    v_pk_fma_f32 v[98:99], v[18:19], v[8:9], v[98:99] op_sel:[0,1,0] op_sel_hi:[1,1,1]
    v_pk_fma_f32 v[100:101], v[20:21], v[8:9], v[100:101] op_sel:[0,1,0] op_sel_hi:[1,1,1]
    v_pk_fma_f32 v[102:103], v[22:23], v[8:9], v[102:103] op_sel:[0,1,0] op_sel_hi:[1,1,1]
    v_pk_fma_f32 v[104:105], v[24:25], v[8:9], v[104:105] op_sel:[0,1,0] op_sel_hi:[1,1,1]
    v_pk_fma_f32 v[106:107], v[26:27], v[8:9], v[106:107] op_sel:[0,1,0] op_sel_hi:[1,1,1]
    v_pk_fma_f32 v[108:109], v[28:29], v[8:9], v[108:109] op_sel:[0,1,0] op_sel_hi:[1,1,1]
    v_pk_fma_f32 v[110:111], v[30:31], v[8:9], v[110:111] op_sel:[0,1,0] op_sel_hi:[1,1,1]
    v_pk_mul_f32 v[96:97], v[96:97], v[48:49]
    v_pk_mul_f32 v[98:99], v[98:99], v[50:51]
    v_pk_mul_f32 v[100:101], v[100:101], v[52:53]
    v_pk_mul_f32 v[102:103], v[102:103], v[54:55]
    v_pk_mul_f32 v[104:105], v[104:105], v[56:57]
    v_pk_mul_f32 v[106:107], v[106:107], v[58:59]
    v_pk_mul_f32 v[108:109], v[108:109], v[60:61]
    v_pk_mul_f32 v[110:111], v[110:111], v[62:63]
    v_cvt_pk_bf16_f32 v96, v96, v97
    v_cvt_pk_bf16_f32 v97, v98, v99
    v_cvt_pk_bf16_f32 v98, v100, v101
    v_cvt_pk_bf16_f32 v99, v102, v103
    v_cvt_pk_bf16_f32 v100, v104, v105
    v_cvt_pk_bf16_f32 v101, v106, v107
    v_cvt_pk_bf16_f32 v102, v108, v109
    v_cvt_pk_bf16_f32 v103, v110, v111
    buffer_store_dwordx4 v[96:99], v145, s[16:19], s53 offen sc1
    buffer_store_dwordx4 v[100:103], v145, s[16:19], s53 offen offset:640 sc1
    s_add_u32 s53, s53, s52
    v_pk_fma_f32 v[112:113], v[32:33], v[8:9], v[112:113] op_sel:[0,0,0] op_sel_hi:[1,0,1]
    v_pk_fma_f32 v[114:115], v[34:35], v[8:9], v[114:115] op_sel:[0,0,0] op_sel_hi:[1,0,1]
    v_pk_fma_f32 v[116:117], v[36:37], v[8:9], v[116:117] op_sel:[0,0,0] op_sel_hi:[1,0,1]
    v_pk_fma_f32 v[118:119], v[38:39], v[8:9], v[118:119] op_sel:[0,0,0] op_sel_hi:[1,0,1]
    v_pk_fma_f32 v[120:121], v[40:41], v[8:9], v[120:121] op_sel:[0,0,0] op_sel_hi:[1,0,1]
    v_pk_fma_f32 v[122:123], v[42:43], v[8:9], v[122:123] op_sel:[0,0,0] op_sel_hi:[1,0,1]
    v_pk_fma_f32 v[124:125], v[44:45], v[8:9], v[124:125] op_sel:[0,0,0] op_sel_hi:[1,0,1]
    v_pk_fma_f32 v[126:127], v[46:47], v[8:9], v[126:127] op_sel:[0,0,0] op_sel_hi:[1,0,1]
    v_pk_mul_f32 v[112:113], v[112:113], v[64:65]
    v_pk_mul_f32 v[114:115], v[114:115], v[66:67]
    v_pk_mul_f32 v[116:117], v[116:117], v[68:69]
    v_pk_mul_f32 v[118:119], v[118:119], v[70:71]
    v_pk_mul_f32 v[120:121], v[120:121], v[72:73]
    v_pk_mul_f32 v[122:123], v[122:123], v[74:75]
    v_pk_mul_f32 v[124:125], v[124:125], v[76:77]
    v_pk_mul_f32 v[126:127], v[126:127], v[78:79]
    v_cvt_pk_bf16_f32 v112, v112, v113
    v_cvt_pk_bf16_f32 v113, v114, v115
    v_cvt_pk_bf16_f32 v114, v116, v117
    v_cvt_pk_bf16_f32 v115, v118, v119
    v_cvt_pk_bf16_f32 v116, v120, v121
    v_cvt_pk_bf16_f32 v117, v122, v123
    v_cvt_pk_bf16_f32 v118, v124, v125
    v_cvt_pk_bf16_f32 v119, v126, v127
    buffer_store_dwordx4 v[112:115], v144, s[16:19], s53 offen sc1
    buffer_store_dwordx4 v[116:119], v144, s[16:19], s53 offen offset:640 sc1
    v_pk_fma_f32 v[128:129], v[32:33], v[8:9], v[128:129] op_sel:[0,1,0] op_sel_hi:[1,1,1]
    v_pk_fma_f32 v[130:131], v[34:35], v[8:9], v[130:131] op_sel:[0,1,0] op_sel_hi:[1,1,1]
    v_pk_fma_f32 v[132:133], v[36:37], v[8:9], v[132:133] op_sel:[0,1,0] op_sel_hi:[1,1,1]
    v_pk_fma_f32 v[134:135], v[38:39], v[8:9], v[134:135] op_sel:[0,1,0] op_sel_hi:[1,1,1]
    v_pk_fma_f32 v[136:137], v[40:41], v[8:9], v[136:137] op_sel:[0,1,0] op_sel_hi:[1,1,1]
    v_pk_fma_f32 v[138:139], v[42:43], v[8:9], v[138:139] op_sel:[0,1,0] op_sel_hi:[1,1,1]
    v_pk_fma_f32 v[140:141], v[44:45], v[8:9], v[140:141] op_sel:[0,1,0] op_sel_hi:[1,1,1]
    v_pk_fma_f32 v[142:143], v[46:47], v[8:9], v[142:143] op_sel:[0,1,0] op_sel_hi:[1,1,1]
    v_pk_mul_f32 v[128:129], v[128:129], v[64:65]
    v_pk_mul_f32 v[130:131], v[130:131], v[66:67]
    v_pk_mul_f32 v[132:133], v[132:133], v[68:69]
    v_pk_mul_f32 v[134:135], v[134:135], v[70:71]
    v_pk_mul_f32 v[136:137], v[136:137], v[72:73]
    v_pk_mul_f32 v[138:139], v[138:139], v[74:75]
    v_pk_mul_f32 v[140:141], v[140:141], v[76:77]
    v_pk_mul_f32 v[142:143], v[142:143], v[78:79]
    v_cvt_pk_bf16_f32 v128, v128, v129
    v_cvt_pk_bf16_f32 v129, v130, v131
    v_cvt_pk_bf16_f32 v130, v132, v133
    v_cvt_pk_bf16_f32 v131, v134, v135
    v_cvt_pk_bf16_f32 v132, v136, v137
    v_cvt_pk_bf16_f32 v133, v138, v139
    v_cvt_pk_bf16_f32 v134, v140, v141
    v_cvt_pk_bf16_f32 v135, v142, v143
    buffer_store_dwordx4 v[128:131], v145, s[16:19], s53 offen sc1
    buffer_store_dwordx4 v[132:135], v145, s[16:19], s53 offen offset:640 sc1
    s_add_u32 s53, s53, s52
    s_branch MK_A_FIN
MK_A_SKIP:
MK_A_FIN:

    v_mov_b32 v148, 162836
    ds_read_b32 v148, v148
    s_waitcnt lgkmcnt(0)
    v_readfirstlane_b32 s86, v148
    s_waitcnt vmcnt(0)
    s_mov_b64 exec, 1
    v_mov_b32 v148, 162824
    v_mov_b32 v149, 1
    ds_add_rtn_u32 v149, v148, v149
    s_waitcnt lgkmcnt(0)
    v_readfirstlane_b32 s55, v149
    s_nop 0
    s_cmp_lg_u32 s55, 3
    s_cbranch_scc1 MK_A_NOS2
    s_mov_b64 exec, -1
    s_mul_i32 s50, s37, 52
    s_lshr_b32 s50, s50, 8
    s_mul_i32 s50, s50, 5
    s_sub_u32 s50, s37, s50
    s_lshl_b32 s50, s50, 7
    s_add_u32 s51, s50, 127
    v_mul_u32_u24 v148, 80, v2
    v_add_u32 v149, 79, v148
    v_cmp_ge_u32 vcc, s51, v148
    v_cmp_le_u32 s[52:53], s50, v149
    s_nop 0
    s_and_b64 exec, vcc, s[52:53]
    s_and_b64 exec, exec, 0xff
    s_lshl_b32 s50, s37, 4
    s_add_u32 s50, s50, s36
    s_lshl_b32 s50, s50, 2
    s_add_u32 s50, s50, 0x1840000
    v_mov_b32 v148, s86
    v_lshlrev_b32 v149, 10, v2
    buffer_store_dword v148, v149, s[16:19], s50 offen sc1
MK_A_NOS2:
    s_mov_b64 exec, -1
    s_setprio 0

    s_mov_b32 s55, 0
MK_ATT:
    s_lshl_b32 s40, s39, 3
    s_add_u32 s40, s40, s33
    s_lshl_b32 s50, s40, 1
    s_mul_i32 s50, s50, 45056
    s_add_u32 s50, s50, 0x1080000
    s_lshr_b32 s51, s38, 1
    s_lshl_b32 s51, s51, 10
    s_and_b32 s52, s38, 1
    s_lshl_b32 s53, s52, 9
    s_add_u32 s51, s51, s53
    s_add_u32 s100, s51, s50
    s_lshr_b32 s53, s38, 3
    s_add_u32 s53, s53, 16
    s_lshl_b32 s53, s53, 10
    s_bfe_u32 s54, s38, 0x20001
    s_lshl_b32 s54, s54, 8
    s_add_u32 s53, s53, s54
    s_lshl_b32 s54, s52, 3
    s_add_u32 s53, s53, s54
    s_add_u32 s101, s53, s50
    v_bfe_u32 v5, v2, 4, 1
    v_mul_u32_u24 v5, 45056, v5
    v_and_b32 v6, 15, v2
    v_lshl_add_u32 v15, v6, 4, v5
    v_lshrrev_b32 v6, 5, v2
    v_lshl_add_u32 v14, v6, 8, v15
    v_and_b32 v3, 31, v2
    v_lshrrev_b32 v4, 5, v2
    v_lshlrev_b32 v96, 4, v2
    v_add_u32 v96, 141312, v96
    v_lshlrev_b32 v5, 3, v3
    v_add_u32 v5, 141312, v5
    s_mov_b32 s56, 0
    s_mov_b32 s57, -1
    v_mov_b32 v6, 145504
    v_cndmask_b32 v97, v5, v6, s[56:57]
    v_mov_b32 v6, 142944
    v_cndmask_b32 v98, v5, v6, s[56:57]
    v_mad_u32_u24 v7, v4, 20, v3
    v_lshlrev_b32 v7, 4, v7
    v_add_u32 v7, 141312, v7
    v_cmp_gt_u32 s[58:59], 20, v3
    v_cmp_eq_u32 s[60:61], 20, v3
    v_cmp_lt_u32 s[62:63], 27, v3

    v_mov_b32 v8, 192
    v_mov_b32 v9, 16
    v_cndmask_b32 v8, v8, v9, s[56:57]
    v_mov_b32 v9, 144
    v_cndmask_b32 v8, v9, v8, s[62:63]
    v_mov_b32 v9, 128
    v_cndmask_b32 v8, v8, v9, s[60:61]
    v_add_u32 v9, 145152, v8
    v_cndmask_b32 v99, v9, v7, s[58:59]
    v_add_u32 v9, 142592, v8
    v_cndmask_b32 v100, v9, v7, s[58:59]
    v_mov_b32 v8, 64
    v_mov_b32 v9, 144
    v_cndmask_b32 v8, v8, v9, s[56:57]
    v_mov_b32 v9, 16
    v_cndmask_b32 v8, v9, v8, s[62:63]
    v_mov_b32 v9, 0
    v_cndmask_b32 v8, v8, v9, s[60:61]
    v_add_u32 v9, 144512, v8
    v_cndmask_b32 v101, v9, v7, s[58:59]
    v_add_u32 v9, 141952, v8
    v_cndmask_b32 v102, v9, v7, s[58:59]
    v_mov_b32 v48, 0
    v_mov_b32 v49, 0
    v_mov_b32 v50, 0
    v_mov_b32 v51, 0
    v_mov_b32 v52, 0
    v_mov_b32 v53, 0
    v_mov_b32 v54, 0
    v_mov_b32 v55, 0
    v_mov_b32 v56, 0
    v_mov_b32 v57, 0
    v_mov_b32 v58, 0
    v_mov_b32 v59, 0
    v_mov_b32 v60, 0
    v_mov_b32 v61, 0
    v_mov_b32 v62, 0
    v_mov_b32 v63, 0
    v_mov_b32 v68, 0
    v_mov_b32 v69, 0
    v_mov_b32 v70, 0
    v_mov_b32 v71, 0
    v_mov_b32 v92, 0
    v_mov_b32 v93, 0
    v_mov_b32 v94, 0
    v_mov_b32 v95, 0
    s_mul_i32 s41, s33, 1280
    s_cmp_ge_u32 s33, 4
    s_mov_b32 s42, 16384
    s_cselect_b32 s42, 60416, s42
    s_add_u32 s41, s41, s42
    v_lshl_add_u32 v8, v2, 4, s41
    v_lshl_add_u32 v9, v3, 3, s41
    v_mov_b32 v13, 145424
    v_cndmask_b32 v9, v9, v13, s[56:57]
    s_lshl_b32 s41, s33, 2
    s_add_u32 s41, s41, 162880
    v_mov_b32 v103, s41
    v_mov_b32 v120, 0
    v_mov_b32 v121, 97376
    v_lshlrev_b32 v122, 4, v2
    s_and_b32 s43, s33, 3
    s_mul_i32 s42, s43, 5120
    s_mul_i32 s43, s43, 5376
    s_cmp_ge_u32 s33, 4
    s_cselect_b32 s44, 3072, 0
    s_add_u32 s42, s42, s44
    s_add_u32 s43, s43, s44
    s_add_u32 s43, s43, 98304
    s_mul_i32 s44, s38, 163840
    s_add_u32 s42, s42, s44
    s_add_u32 s42, s42, 0x285000
    s_mov_b32 s49, 0

    s_lshl_b32 s5, s38, 3
    s_add_u32 s5, s5, s33
    s_mul_i32 s50, s5, 205
    s_lshr_b32 s50, s50, 10
    s_mul_i32 s51, s50, 5
    s_sub_u32 s51, s5, s51
    s_mul_i32 s52, s39, 5
    s_add_u32 s51, s51, s52
    s_mul_i32 s4, s39, 220
    s_add_u32 s4, s4, s5
    s_lshl_b32 s4, s4, 10
    s_add_u32 s4, s4, 0x1600000
    s_sub_u32 s52, s50, 20
    s_lshl_b32 s52, s52, 5
    s_mov_b32 s53, 16
    s_mov_b32 s54, 4
    s_mov_b32 s3, 10240
    s_sub_u32 s6, s50, 16
    s_mul_i32 s6, s6, 160
    s_add_u32 s6, s6, 16
    s_cmp_lt_u32 s50, 20
    s_cselect_b32 s52, s6, s52
    s_cselect_b32 s53, 80, s53
    s_cselect_b32 s54, 40, s54
    s_cselect_b32 s3, 25600, s3
    s_cselect_b32 s20, s68, s78
    s_cselect_b32 s21, s69, s79
    s_mov_b32 s22, 0xf0000
    s_cselect_b32 s22, 0xc8000, s22
    s_mov_b32 s23, 0x00020000
    s_mul_i32 s6, s50, 40
    s_cmp_lt_u32 s50, 16
    s_cselect_b32 s52, s6, s52
    s_cselect_b32 s53, 20, s53
    s_cselect_b32 s54, 4, s54
    s_cselect_b32 s3, 10240, s3
    v_mul_u32_u24 v16, s53, v4
    v_bfe_u32 v17, v2, 4, 1
    v_mul_u32_u24 v17, s54, v17
    v_add3_u32 v16, v16, v17, s52
    v_mul_u32_u24 v16, 1280, v16
    v_and_b32 v17, 15, v2
    v_lshlrev_b32 v17, 1, v17
    s_lshl_b32 s51, s51, 5
    v_add3_u32 v10, v16, v17, s51
    v_mov_b32 v16, 162836
    ds_read_b32 v16, v16
    s_waitcnt lgkmcnt(0)
    v_readfirstlane_b32 s86, v16
    s_cmp_ge_u32 s33, 4
    s_cbranch_scc1 MK_RDY
    s_min_u32 s51, s33, 2
    v_and_b32 v16, 15, v2
    v_lshrrev_b32 v17, 4, v2
    v_mul_u32_u24 v17, 5376, v17
    v_lshl_add_u32 v17, v16, 4, v17
    s_mul_i32 s50, s51, 21504
    s_add_u32 s50, s50, 103424
    v_add_u32 v17, s50, v17
    v_and_b32 v18, 7, v2
    v_cmp_eq_u32 vcc, 0, v18
    v_mov_b32 v19, 0x3f803f80
    s_nop 0
    v_cndmask_b32 v21, 0, v19, vcc
    v_mov_b32 v22, v21
    v_mov_b32 v23, v21
    v_cmp_eq_u32 vcc, 6, v16
    s_nop 1
    v_cndmask_b32 v20, v21, v19, vcc
    ds_write_b128 v17, v[20:23]
    s_mul_i32 s94, s38, 163840
    s_mul_i32 s95, s33, 5120
    s_add_u32 s94, s94, s95
    s_add_u32 s94, s94, 0x280000
    s_add_u32 s96, s94, 4096
    s_mul_i32 s95, s33, 5376
    s_add_u32 s95, s95, 141312
    s_lshl_b32 s97, s38, 3
    s_add_u32 s97, s97, s39
    s_mul_i32 s97, s97, 10240
    s_lshr_b32 s98, s33, 1
    s_mul_i32 s99, s98, 5120
    s_add_u32 s97, s97, s99
    s_mul_i32 s98, s98, 49152
    s_add_u32 s98, s98, 16384
    s_and_b32 s99, s33, 1
    s_lshl_b32 s99, s99, 11
    s_add_u32 s97, s97, s99
    s_add_u32 s98, s98, s99
    v_mov_b32 v24, 162840
    s_cmp_lg_u32 s33, 0
    s_cbranch_scc1 MK_S2W
    s_mul_i32 s50, s38, 20
    s_add_u32 s51, s50, 19
    s_lshr_b32 s50, s50, 7
    s_lshr_b32 s51, s51, 7
    v_mov_b32 v16, s50
    v_mov_b32 v17, s51
    v_and_b32 v18, 16, v2
    v_cmp_ne_u32 vcc, 0, v18
    s_nop 1
    v_cndmask_b32 v16, v16, v17, vcc
    v_lshlrev_b32 v16, 6, v16
    v_lshrrev_b32 v18, 5, v2
    v_mul_u32_u24 v18, 320, v18
    v_add3_u32 v17, v16, v18, 64
    v_and_b32 v18, 15, v2
    v_lshl_add_u32 v20, v18, 2, v17
    v_and_b32 v18, 1, v2
    v_lshl_add_u32 v17, v18, 2, v17
    v_and_b32 v18, 1, v2
    v_lshl_add_u32 v16, v18, 2, v16
    s_lshl_b32 s50, s39, 3
    v_add_u32 v16, s50, v16
    s_lshl_b32 s51, s34, 10
    s_add_u32 s51, s51, 0x1840000
    s_mov_b32 s52, 0
MK_S2P:
    s_sleep 6
    buffer_load_dword v18, v16, s[16:19], s51 offen sc1
    buffer_load_dword v19, v17, s[16:19], s51 offen offset:256 sc1
    s_waitcnt vmcnt(0)
    v_xor_b32 v18, s86, v18
    v_xor_b32 v19, s86, v19
    v_or_b32 v18, v18, v19
    v_cmp_ne_u32 vcc, 0, v18
    s_cbranch_vccz MK_S2P_OK
    s_add_u32 s52, s52, 1
    s_cmp_lt_u32 s52, 200000
    s_cbranch_scc1 MK_S2P
MK_S2P_OK:
    ds_write_b32 v24, v24
    s_branch MK_S2G
MK_S2W:
    s_sleep 1
    ds_read_b32 v25, v24
    s_waitcnt lgkmcnt(0)
    v_cmp_eq_u32 vcc, 0, v25
    s_cbranch_vccnz MK_S2W
MK_S2G:
    s_mov_b32 m0, s98

    s_nop 0
    buffer_load_dwordx4 v122, s[16:19], s97 offen offset:0 sc1 lds
    buffer_load_dwordx4 v122, s[16:19], s97 offen offset:1024 sc1 lds
    buffer_load_dwordx4 v122, s[16:19], s97 offen offset:2048 sc1 lds
    s_mov_b32 m0, s95
    s_nop 0
    buffer_load_dwordx4 v122, s[16:19], s94 offen offset:0 sc1 lds
    buffer_load_dwordx4 v122, s[16:19], s94 offen offset:1024 sc1 lds
    buffer_load_dwordx4 v122, s[16:19], s94 offen offset:2048 sc1 lds
    buffer_load_dwordx4 v122, s[16:19], s94 offen offset:3072 sc1 lds
    s_add_u32 m0, s95, 4096
    s_nop 0
    buffer_load_dwordx4 v122, s[16:19], s96 offen sc1 lds
    s_sub_u32 s95, s95, 43008
    s_add_u32 s94, s94, 20480
    s_add_u32 s96, s96, 20480
    s_cmp_lg_u32 s33, 0
    s_cbranch_scc1 MK_S2Q_OK
    s_add_u32 s51, s51, 256
    s_mov_b32 s52, 0
MK_S2Q:
    buffer_load_dword v19, v20, s[16:19], s51 offen sc1
    s_waitcnt vmcnt(0)
    v_cmp_ne_u32 vcc, s86, v19
    s_cbranch_vccz MK_S2Q_OK
    s_add_u32 s52, s52, 1
    s_cmp_gt_u32 s52, 200000
    s_cbranch_scc1 MK_S2Q_OK
    s_sleep 2
    s_branch MK_S2Q
MK_S2Q_OK:

    s_waitcnt vmcnt(0)
    ds_write_b32 v103, v103
MK_RDY:
    ds_read_b128 v[124:127], v121 offset:65504
    s_waitcnt lgkmcnt(0)
    v_min3_u32 v124, v124, v125, v126
    v_min_u32 v124, v124, v127
    v_cmp_eq_u32 vcc, 0, v124
    s_cbranch_vccz MK_RDYD
    s_sleep 1
    s_branch MK_RDY
MK_RDYD:
    s_and_b32 s96, s33, 3
    s_mul_i32 s97, s96, 5120
    s_mul_i32 s96, s39, 225280
    s_add_u32 s97, s97, s96
    s_cmp_ge_u32 s33, 4
    s_cselect_b32 s96, 3072, 0
    s_add_u32 s97, s97, s96
    s_add_u32 s97, s97, 0x1600000
    s_setprio 3
    v_and_b32 v121, 7, v2
    v_lshlrev_b32 v121, 2, v121
    v_add_u32 v121, 162912, v121
    s_mov_b32 s7, 0x1bc

    ds_read_b128 v[72:75], v8
    ds_read_b64 v[76:77], v9 offset:1024
    ds_read_b128 v[80:83], v96 offset:2560
    ds_read_b64 v[84:85], v98 offset:3584
    s_add_u32 m0, s43, s49
    s_cmp_ge_u32 s33, 4
    buffer_load_dwordx4 v122, s[16:19], s42 offen sc1 lds
    buffer_load_dwordx4 v122, s[16:19], s42 offen offset:1024 sc1 lds
    s_cbranch_scc1 MK_KV1
    buffer_load_dwordx4 v122, s[16:19], s42 offen offset:2048 sc1 lds
MK_KV1:
    s_add_u32 s42, s42, 20480
    s_add_u32 s49, s49, 21504
    s_cmp_eq_u32 s49, 64512
    s_cselect_b32 s49, 0, s49
    s_waitcnt lgkmcnt(0)
    v_mfma_f32_32x32x16_bf16 v[32:47], v[80:83], v[72:75], 0
    v_mfma_f32_32x32x8_bf16 v[32:47], v[84:85], v[76:77], v[32:47]
    ds_read_b128 v[80:83], v96 offset:0
    ds_read_b64 v[84:85], v97 offset:1024
    s_waitcnt lgkmcnt(0)
    v_mfma_f32_32x32x16_bf16 v[16:31], v[80:83], v[72:75], 0
    v_mfma_f32_32x32x8_bf16 v[16:31], v[84:85], v[76:77], v[16:31]
    s_nop 6
    v_max3_f32 v104, v32, v33, v34
    v_max_f32 v104, v104, v47
    v_max3_f32 v104, v104, v35, v36
    v_max3_f32 v104, v104, v37, v38
    v_max3_f32 v104, v104, v39, v40
    v_max3_f32 v104, v104, v41, v42
    v_max3_f32 v104, v104, v43, v44
    v_max3_f32 v104, v104, v45, v46
    v_max3_f32 v104, v104, v16, v17
    v_max3_f32 v104, v104, v18, v19
    v_max3_f32 v104, v104, v20, v21
    v_max3_f32 v104, v104, v22, v23
    v_max3_f32 v104, v104, v24, v25
    v_max3_f32 v104, v104, v26, v27
    v_max3_f32 v104, v104, v28, v29
    v_max3_f32 v104, v104, v30, v31
    v_mov_b32 v106, v104
    s_nop 1
    v_permlane32_swap_b32 v104, v106
    v_max_f32 v104, v104, v106
    v_ceil_f32 v104, v104
    v_add_f32 v104, 0x42a00000, v104
    v_sub_f32 v106, 0, v104
    v_and_b32 v107, 0xffff0000, v106
    v_sub_f32 v106, v106, v107
    v_cvt_pk_bf16_f32 v108, v107, v106
    v_and_b32 v106, 0xffff0000, v108
    v_add_f32 v106, v106, v107
    v_sub_f32 v104, 0, v106
    v_cndmask_b32 v76, v76, v108, s[56:57]
    v_mfma_f32_32x32x16_bf16 v[16:31], v[80:83], v[72:75], 0
    s_nop 0
    v_mfma_f32_32x32x8_bf16 v[16:31], v[84:85], v[76:77], v[16:31]
    ds_read_b128 v[80:83], v96 offset:2560
    ds_read_b64 v[84:85], v98 offset:3584
    ds_read_b128 v[88:91], v99 offset:1280
    s_mov_b32 s44, 2
    s_mov_b32 s45, 8
    s_mov_b32 s46, 0
    s_mov_b32 s47, 0x49800000

    s_waitcnt lgkmcnt(0)
.p2align 4

MK_AL:
    s_waitcnt lgkmcnt(2)
    v_mfma_f32_32x32x16_bf16 v[32:47], v[80:83], v[72:75], 0
    ds_read_b128 v[80:83], v96 offset:5376
    s_nop 0
    v_exp_f32 v16, v16
    v_exp_f32 v17, v17
    v_exp_f32 v18, v18
    v_exp_f32 v19, v19
    v_exp_f32 v20, v20
    v_mfma_f32_32x32x16_bf16 v[48:63], v[92:95], v[68:71], v[48:63]
    ds_read_b128 v[92:95], v101 offset:1920
    v_exp_f32 v21, v21
    v_exp_f32 v22, v22
    v_exp_f32 v23, v23
    v_cvt_pk_bf16_f32 v64, v16, v17
    v_cvt_pk_bf16_f32 v65, v18, v19
    v_cvt_pk_bf16_f32 v66, v20, v21
    v_cvt_pk_bf16_f32 v67, v22, v23
    s_waitcnt lgkmcnt(2)
    v_mfma_f32_32x32x8_bf16 v[32:47], v[84:85], v[76:77], v[32:47]
    ds_read_b64 v[84:85], v97 offset:6400
    v_exp_f32 v24, v24
    v_exp_f32 v25, v25
    v_exp_f32 v26, v26
    v_exp_f32 v27, v27
    v_exp_f32 v28, v28
    v_mfma_f32_32x32x16_bf16 v[48:63], v[88:91], v[64:67], v[48:63]
    ds_read_b128 v[88:91], v100 offset:3840
    v_exp_f32 v29, v29
    v_exp_f32 v30, v30
    v_exp_f32 v31, v31
    v_cvt_pk_bf16_f32 v68, v24, v25
    v_cvt_pk_bf16_f32 v69, v26, v27
    v_cvt_pk_bf16_f32 v70, v28, v29
    v_cvt_pk_bf16_f32 v71, v30, v31
    s_waitcnt lgkmcnt(2)
    v_mfma_f32_32x32x16_bf16 v[16:31], v[80:83], v[72:75], 0
    ds_read_b128 v[80:83], v96 offset:7936
    v_exp_f32 v32, v32
    v_exp_f32 v33, v33
    v_exp_f32 v34, v34
    v_exp_f32 v35, v35
    v_exp_f32 v36, v36
    v_cmp_lt_f32 vcc, s47, abs(v56)
    s_cbranch_vccnz MK_RC1
MK_RCB1:
    v_mfma_f32_32x32x16_bf16 v[48:63], v[92:95], v[68:71], v[48:63]
    ds_read_b128 v[92:95], v102 offset:4480
    v_exp_f32 v37, v37
    v_exp_f32 v38, v38
    v_exp_f32 v39, v39
    v_cvt_pk_bf16_f32 v64, v32, v33
    v_cvt_pk_bf16_f32 v65, v34, v35
    v_cvt_pk_bf16_f32 v66, v36, v37
    v_cvt_pk_bf16_f32 v67, v38, v39
    s_waitcnt lgkmcnt(2)
    v_mfma_f32_32x32x8_bf16 v[16:31], v[84:85], v[76:77], v[16:31]
    ds_read_b64 v[84:85], v98 offset:8960
    v_exp_f32 v40, v40
    v_exp_f32 v41, v41
    v_exp_f32 v42, v42
    v_exp_f32 v43, v43
    v_exp_f32 v44, v44
    v_mfma_f32_32x32x16_bf16 v[48:63], v[88:91], v[64:67], v[48:63]
    ds_read_b128 v[88:91], v99 offset:6656
    v_exp_f32 v45, v45
    v_exp_f32 v46, v46
    v_exp_f32 v47, v47
    v_cvt_pk_bf16_f32 v68, v40, v41
    v_cvt_pk_bf16_f32 v69, v42, v43
    v_cvt_pk_bf16_f32 v70, v44, v45
    v_cvt_pk_bf16_f32 v71, v46, v47
    s_waitcnt lgkmcnt(2)
    v_mfma_f32_32x32x16_bf16 v[32:47], v[80:83], v[72:75], 0
    ds_read_b128 v[80:83], v96 offset:10752
    s_setprio 2
    v_exp_f32 v16, v16
    v_exp_f32 v17, v17
    v_exp_f32 v18, v18
    v_exp_f32 v19, v19
    v_exp_f32 v20, v20
    v_mfma_f32_32x32x16_bf16 v[48:63], v[92:95], v[68:71], v[48:63]
    ds_read_b128 v[92:95], v101 offset:7296
    v_exp_f32 v21, v21
    v_exp_f32 v22, v22
    v_exp_f32 v23, v23
    v_cvt_pk_bf16_f32 v64, v16, v17
    v_cvt_pk_bf16_f32 v65, v18, v19
    v_cvt_pk_bf16_f32 v66, v20, v21
    v_cvt_pk_bf16_f32 v67, v22, v23
    s_waitcnt lgkmcnt(2)
    v_mfma_f32_32x32x8_bf16 v[32:47], v[84:85], v[76:77], v[32:47]
    ds_read_b64 v[84:85], v97 offset:11776
    v_exp_f32 v24, v24
    v_exp_f32 v25, v25
    v_exp_f32 v26, v26
    v_exp_f32 v27, v27
    v_exp_f32 v28, v28
    s_cmp_lg_u32 s46, 0
    s_cbranch_scc1 MK_RS2
MK_RSB2:
    v_mfma_f32_32x32x16_bf16 v[48:63], v[88:91], v[64:67], v[48:63]
    ds_read_b128 v[88:91], v100 offset:9216
    v_exp_f32 v29, v29
    v_exp_f32 v30, v30
    v_exp_f32 v31, v31
    v_cvt_pk_bf16_f32 v68, v24, v25
    v_cvt_pk_bf16_f32 v69, v26, v27
    v_cvt_pk_bf16_f32 v70, v28, v29
    v_cvt_pk_bf16_f32 v71, v30, v31
    v_add_u32 v120, 1, v120
    s_waitcnt vmcnt(0) lgkmcnt(2)
    v_mfma_f32_32x32x16_bf16 v[16:31], v[80:83], v[72:75], 0
    ds_read_b128 v[80:83], v96 offset:13312
    ds_write_b32 v103, v120 offset:32
    v_exp_f32 v32, v32
    v_exp_f32 v33, v33
    v_exp_f32 v34, v34
    v_exp_f32 v35, v35
    v_exp_f32 v36, v36
    v_mfma_f32_32x32x16_bf16 v[48:63], v[92:95], v[68:71], v[48:63]
    ds_read_b128 v[92:95], v102 offset:9856
    v_exp_f32 v37, v37
    v_exp_f32 v38, v38
    v_exp_f32 v39, v39
    v_cvt_pk_bf16_f32 v64, v32, v33
    v_cvt_pk_bf16_f32 v65, v34, v35
    v_cvt_pk_bf16_f32 v66, v36, v37
    v_cvt_pk_bf16_f32 v67, v38, v39
    s_waitcnt lgkmcnt(2)
    v_mfma_f32_32x32x8_bf16 v[16:31], v[84:85], v[76:77], v[16:31]
    ds_read_b64 v[84:85], v98 offset:14336
    v_exp_f32 v40, v40
    v_exp_f32 v41, v41
    v_exp_f32 v42, v42
    v_exp_f32 v43, v43
    v_exp_f32 v44, v44
    v_mfma_f32_32x32x16_bf16 v[48:63], v[88:91], v[64:67], v[48:63]
    ds_read_b128 v[88:91], v99 offset:12032
    v_exp_f32 v45, v45
    v_exp_f32 v46, v46
    v_exp_f32 v47, v47
    v_cvt_pk_bf16_f32 v68, v40, v41
    v_cvt_pk_bf16_f32 v69, v42, v43
    v_cvt_pk_bf16_f32 v70, v44, v45
    v_cvt_pk_bf16_f32 v71, v46, v47
    s_waitcnt lgkmcnt(2)
    v_mfma_f32_32x32x16_bf16 v[32:47], v[80:83], v[72:75], 0
    ds_read_b128 v[80:83], v96 offset:16128
    s_bitcmp1_b32 s7, s45
    s_cbranch_scc1 MK_STH
MK_STB:
    v_exp_f32 v16, v16
    v_exp_f32 v17, v17
    v_exp_f32 v18, v18
    v_exp_f32 v19, v19
    v_exp_f32 v20, v20
    v_mfma_f32_32x32x16_bf16 v[48:63], v[92:95], v[68:71], v[48:63]
    ds_read_b128 v[92:95], v101 offset:12672
    v_exp_f32 v21, v21
    v_exp_f32 v22, v22
    v_exp_f32 v23, v23
    v_cvt_pk_bf16_f32 v64, v16, v17
    v_cvt_pk_bf16_f32 v65, v18, v19
    v_cvt_pk_bf16_f32 v66, v20, v21
    v_cvt_pk_bf16_f32 v67, v22, v23
    s_waitcnt lgkmcnt(2)
    v_mfma_f32_32x32x8_bf16 v[32:47], v[84:85], v[76:77], v[32:47]
    ds_read_b64 v[84:85], v97 offset:17152
    v_exp_f32 v24, v24
    v_exp_f32 v25, v25
    v_exp_f32 v26, v26
    v_exp_f32 v27, v27
    v_exp_f32 v28, v28
    v_mfma_f32_32x32x16_bf16 v[48:63], v[88:91], v[64:67], v[48:63]
    ds_read_b128 v[88:91], v100 offset:14592
    v_exp_f32 v29, v29
    v_exp_f32 v30, v30
    v_exp_f32 v31, v31
    v_cvt_pk_bf16_f32 v68, v24, v25
    v_cvt_pk_bf16_f32 v69, v26, v27
    v_cvt_pk_bf16_f32 v70, v28, v29
    v_cvt_pk_bf16_f32 v71, v30, v31
    s_waitcnt lgkmcnt(2)
    v_mfma_f32_32x32x16_bf16 v[16:31], v[80:83], v[72:75], 0
    ds_read_b128 v[80:83], v96 offset:18688
    s_setprio 1
    v_exp_f32 v32, v32
    v_exp_f32 v33, v33
    v_exp_f32 v34, v34
    v_exp_f32 v35, v35
    v_exp_f32 v36, v36
    v_mfma_f32_32x32x16_bf16 v[48:63], v[92:95], v[68:71], v[48:63]
    ds_read_b128 v[92:95], v102 offset:15232
    v_exp_f32 v37, v37
    v_exp_f32 v38, v38
    v_exp_f32 v39, v39
    v_cvt_pk_bf16_f32 v64, v32, v33
    v_cvt_pk_bf16_f32 v65, v34, v35
    v_cvt_pk_bf16_f32 v66, v36, v37
    v_cvt_pk_bf16_f32 v67, v38, v39
    s_waitcnt lgkmcnt(2)
    v_mfma_f32_32x32x8_bf16 v[16:31], v[84:85], v[76:77], v[16:31]
    ds_read_b64 v[84:85], v98 offset:19712
    ds_read_b32 v124, v121
    v_exp_f32 v40, v40
    v_exp_f32 v41, v41
    v_exp_f32 v42, v42
    v_exp_f32 v43, v43
    v_exp_f32 v44, v44
    v_mfma_f32_32x32x16_bf16 v[48:63], v[88:91], v[64:67], v[48:63]
    ds_read_b128 v[88:91], v99 offset:17408
    v_exp_f32 v45, v45
    v_exp_f32 v46, v46
    v_exp_f32 v47, v47
    v_cvt_pk_bf16_f32 v68, v40, v41
    v_cvt_pk_bf16_f32 v69, v42, v43
    v_cvt_pk_bf16_f32 v70, v44, v45
    v_cvt_pk_bf16_f32 v71, v46, v47
    s_add_u32 s44, s44, 1
    s_cmp_eq_u32 s44, 3
    s_mov_b32 s48, 21504
    s_cselect_b32 s48, 0xffff5800, s48
    s_cselect_b32 s44, 0, s44
    v_add_u32 v96, s48, v96
    v_add_u32 v97, s48, v97
    v_add_u32 v98, s48, v98

    s_waitcnt lgkmcnt(1)
MK_PCK:
    v_cmp_lt_u32 vcc, v124, v120
    s_cbranch_vccnz MK_PSPIN
    v_mfma_f32_32x32x16_bf16 v[32:47], v[80:83], v[72:75], 0
    ds_read_b128 v[80:83], v96 offset:0
    s_setprio 3
    v_exp_f32 v16, v16
    v_exp_f32 v17, v17
    v_exp_f32 v18, v18
    v_exp_f32 v19, v19
    v_exp_f32 v20, v20
    v_mfma_f32_32x32x16_bf16 v[48:63], v[92:95], v[68:71], v[48:63]
    ds_read_b128 v[92:95], v101 offset:18048
    s_cmp_le_u32 s45, 2
    s_cbranch_scc1 MK_WR
    s_add_u32 m0, s43, s49
    s_cmp_ge_u32 s33, 4
    buffer_load_dwordx4 v122, s[16:19], s42 offen sc1 lds
    buffer_load_dwordx4 v122, s[16:19], s42 offen offset:1024 sc1 lds
    s_cbranch_scc1 MK_KV2
    buffer_load_dwordx4 v122, s[16:19], s42 offen offset:2048 sc1 lds
MK_KV2:
    s_add_u32 s42, s42, 20480
    s_add_u32 s49, s49, 21504
    s_cmp_eq_u32 s49, 64512
    s_cselect_b32 s49, 0, s49
MK_KVS:
    v_exp_f32 v21, v21
    v_exp_f32 v22, v22
    v_exp_f32 v23, v23
    v_cvt_pk_bf16_f32 v64, v16, v17
    v_cvt_pk_bf16_f32 v65, v18, v19
    v_cvt_pk_bf16_f32 v66, v20, v21
    v_cvt_pk_bf16_f32 v67, v22, v23
    s_waitcnt lgkmcnt(2)
    v_mfma_f32_32x32x8_bf16 v[32:47], v[84:85], v[76:77], v[32:47]
    ds_read_b64 v[84:85], v97 offset:1024
    v_exp_f32 v24, v24
    v_exp_f32 v25, v25
    v_exp_f32 v26, v26
    v_exp_f32 v27, v27
    v_exp_f32 v28, v28
    v_mfma_f32_32x32x16_bf16 v[48:63], v[88:91], v[64:67], v[48:63]
    ds_read_b128 v[88:91], v100 offset:19968
    v_exp_f32 v29, v29
    v_exp_f32 v30, v30
    v_exp_f32 v31, v31
    v_cvt_pk_bf16_f32 v68, v24, v25
    v_cvt_pk_bf16_f32 v69, v26, v27
    v_cvt_pk_bf16_f32 v70, v28, v29
    v_cvt_pk_bf16_f32 v71, v30, v31
    v_add_u32 v99, s48, v99
    v_add_u32 v100, s48, v100
    s_waitcnt lgkmcnt(2)
    v_mfma_f32_32x32x16_bf16 v[16:31], v[80:83], v[72:75], 0
    ds_read_b128 v[80:83], v96 offset:2560
    v_exp_f32 v32, v32
    v_exp_f32 v33, v33
    v_exp_f32 v34, v34
    v_exp_f32 v35, v35
    v_exp_f32 v36, v36
    v_mfma_f32_32x32x16_bf16 v[48:63], v[92:95], v[68:71], v[48:63]
    ds_read_b128 v[92:95], v102 offset:20608
    v_exp_f32 v37, v37
    v_exp_f32 v38, v38
    v_exp_f32 v39, v39
    v_cvt_pk_bf16_f32 v64, v32, v33
    v_cvt_pk_bf16_f32 v65, v34, v35
    v_cvt_pk_bf16_f32 v66, v36, v37
    v_cvt_pk_bf16_f32 v67, v38, v39
    s_waitcnt lgkmcnt(2)
    v_mfma_f32_32x32x8_bf16 v[16:31], v[84:85], v[76:77], v[16:31]
    ds_read_b64 v[84:85], v98 offset:3584
    v_exp_f32 v40, v40
    v_exp_f32 v41, v41
    v_exp_f32 v42, v42
    v_exp_f32 v43, v43
    v_exp_f32 v44, v44
    v_mfma_f32_32x32x16_bf16 v[48:63], v[88:91], v[64:67], v[48:63]
    ds_read_b128 v[88:91], v99 offset:1280
    v_exp_f32 v45, v45
    v_exp_f32 v46, v46
    v_exp_f32 v47, v47
    v_cvt_pk_bf16_f32 v68, v40, v41
    v_cvt_pk_bf16_f32 v69, v42, v43
    v_cvt_pk_bf16_f32 v70, v44, v45
    v_cvt_pk_bf16_f32 v71, v46, v47
    v_add_u32 v101, s48, v101
    v_add_u32 v102, s48, v102
    s_sub_u32 s45, s45, 1
    s_cmp_lg_u32 s45, 0
    s_cbranch_scc1 MK_AL
    s_waitcnt lgkmcnt(0)
    v_mfma_f32_32x32x16_bf16 v[48:63], v[92:95], v[68:71], v[48:63]

MK_ATT_FIN:
    s_nop 7
    s_nop 3
    v_mov_b32 v106, v56
    v_mov_b32 v107, v56
    s_nop 1
    v_permlane32_swap_b32 v106, v107
    v_rcp_f32 v110, v107
    s_cmp_lg_u32 s45, 0
    s_cbranch_scc1 MK_ATT_OK
    v_max_f32 v108, abs(v48), abs(v48)
    v_maximum3_f32 v108, v108, abs(v48), abs(v49)
    v_maximum3_f32 v108, v108, abs(v50), abs(v51)
    v_maximum3_f32 v108, v108, abs(v52), abs(v53)
    v_maximum3_f32 v108, v108, abs(v54), abs(v55)
    v_maximum3_f32 v108, v108, abs(v56), abs(v57)
    v_maximum3_f32 v108, v108, abs(v58), abs(v59)
    s_mov_b32 s54, 0x7b800000
    s_mov_b32 s55, 0x9800000
    v_cmp_ngt_f32 vcc, s54, v108
    s_cbranch_vccnz MK_SLOW
    v_min_f32 v108, v108, v107
    v_cmp_nlt_f32 vcc, s55, v108
    s_cbranch_vccnz MK_SLOW
MK_ATT_OK:
    v_mul_f32 v48, v48, v110
    v_mul_f32 v49, v49, v110
    v_mul_f32 v50, v50, v110
    v_mul_f32 v51, v51, v110
    v_mul_f32 v52, v52, v110
    v_mul_f32 v53, v53, v110
    v_mul_f32 v54, v54, v110
    v_mul_f32 v55, v55, v110
    v_mul_f32 v56, v56, v110
    v_mul_f32 v57, v57, v110
    v_mul_f32 v58, v58, v110
    v_mul_f32 v59, v59, v110
    v_cvt_pk_bf16_f32 v48, v48, v49
    v_cvt_pk_bf16_f32 v49, v50, v51
    v_cvt_pk_bf16_f32 v50, v52, v53
    v_cvt_pk_bf16_f32 v51, v54, v55
    v_cvt_pk_bf16_f32 v52, v56, v57
    v_cvt_pk_bf16_f32 v53, v58, v59
    buffer_store_dwordx4 v[48:51], v14, s[16:19], s100 offen sc1
    s_mov_b32 exec_hi, 0
    buffer_store_dwordx2 v[52:53], v15, s[16:19], s101 offen sc1
    s_mov_b32 exec_hi, -1
    s_setprio 0
    s_branch MK_AB3
MK_STH:
    s_cmp_eq_u32 s45, 8
    s_cbranch_scc1 MK_H0
    s_cmp_eq_u32 s45, 7
    s_cbranch_scc1 MK_H1
    s_cmp_eq_u32 s45, 5
    s_cbranch_scc1 MK_H3
    s_cmp_lg_u32 s45, 4
    s_cbranch_scc1 MK_H5
    s_lshl_b32 s94, s34, 10
    s_lshl_b32 s50, s39, 7
    s_add_u32 s94, s94, s50
    s_add_u32 s94, s94, 0x1842000
    v_lshlrev_b32 v132, 2, v3
    buffer_load_dword v133, v132, s[16:19], s94 offen sc1
    s_and_b32 s95, s35, 3
    s_lshl_b32 s95, s95, 3
    s_add_u32 s95, s95, s33
    s_mul_i32 s95, s95, 0
    s_mul_i32 s50, s39, 225280
    s_add_u32 s95, s95, s50
    s_add_u32 s95, s95, 0x1619000
    v_lshlrev_b32 v134, 7, v2
    s_branch MK_STB
MK_H5:
    v_cmp_ne_u32 vcc, s86, v133
    s_cbranch_vccz MK_S3P_OK
    s_mov_b32 s50, 0
MK_S3P:
    buffer_load_dword v133, v132, s[16:19], s94 offen sc1
    s_waitcnt vmcnt(0)
    v_cmp_ne_u32 vcc, s86, v133
    s_cbranch_vccz MK_S3P_OK
    s_add_u32 s50, s50, 1
    s_cmp_gt_u32 s50, 200000
    s_cbranch_scc1 MK_S3P_OK
    s_sleep 2
    s_branch MK_S3P
MK_S3P_OK:
    s_branch MK_STB
MK_H0:
    buffer_load_ushort v132, v10, s[20:23], 0 offen offset:0
    buffer_load_ushort v133, v10, s[20:23], 0 offen offset:1280
    buffer_load_ushort v134, v10, s[20:23], 0 offen offset:2560
    buffer_load_ushort v135, v10, s[20:23], 0 offen offset:3840
    buffer_load_ushort v136, v10, s[20:23], s3 offen offset:0
    buffer_load_ushort v137, v10, s[20:23], s3 offen offset:1280
    buffer_load_ushort v138, v10, s[20:23], s3 offen offset:2560
    buffer_load_ushort v139, v10, s[20:23], s3 offen offset:3840
    s_branch MK_STB
MK_H1:
    s_cmp_ge_u32 s5, 220
    s_cbranch_scc1 MK_H1B
    v_lshl_or_b32 v132, v133, 16, v132
    v_lshl_or_b32 v133, v135, 16, v134
    v_lshl_or_b32 v134, v137, 16, v136
    v_lshl_or_b32 v135, v139, 16, v138
    buffer_store_dwordx4 v[132:135], v122, s[16:19], s4 offen sc1
MK_H1B:
    s_cmp_eq_u32 s55, 0
    s_cbranch_scc1 MK_NOZ1
    s_add_u32 s54, s55, 4096
    buffer_store_dwordx4 v[140:143], v122, s[16:19], s55 offen offset:0 sc1
    buffer_store_dwordx4 v[144:147], v122, s[16:19], s55 offen offset:1024 sc1
    buffer_store_dwordx4 v[148:151], v122, s[16:19], s55 offen offset:2048 sc1
    buffer_store_dwordx4 v[152:155], v122, s[16:19], s55 offen offset:3072 sc1
    buffer_store_dwordx4 v[156:159], v122, s[16:19], s54 offen offset:0 sc1
    buffer_store_dwordx4 v[160:163], v122, s[16:19], s54 offen offset:1024 sc1
MK_NOZ1:
    s_branch MK_STB
MK_H3:
    s_cmp_lg_u32 s33, 0
    s_cbranch_scc1 MK_STB
    s_mov_b64 exec, 0x1ff
    s_lshl_b32 s50, s39, 5
    s_add_u32 s50, s50, s38
    s_lshl_b32 s50, s50, 2
    v_lshl_add_u32 v137, v2, 10, s50
    s_lshr_b32 s50, s36, 1
    s_lshl_b32 s50, s50, 8
    s_and_b32 s51, s36, 1
    s_lshl_b32 s51, s51, 4
    s_add_u32 s50, s50, s51
    s_add_u32 s50, s50, s32
    s_lshl_b32 s50, s50, 2
    s_add_u32 s50, s50, 32768
    v_writelane_b32 v137, s50, 8
    v_mov_b32 v136, s86
    s_mov_b32 s50, 0x1842000
    buffer_store_dword v136, v137, s[16:19], s50 offen sc1
    s_mov_b64 exec, -1
    s_branch MK_STB
MK_WR:
    s_add_u32 m0, s43, s49
    s_cmp_ge_u32 s33, 4
    buffer_load_dwordx4 v122, s[16:19], s97 offen sc1 lds
    buffer_load_dwordx4 v122, s[16:19], s97 offen offset:1024 sc1 lds
    s_cbranch_scc1 MK_WR1
    buffer_load_dwordx4 v122, s[16:19], s97 offen offset:2048 sc1 lds
MK_WR1:
    s_add_u32 s97, s97, 20480
    s_add_u32 s49, s49, 21504
    s_cmp_eq_u32 s49, 64512
    s_cselect_b32 s49, 0, s49
    s_branch MK_KVS
MK_PSPIN:
    s_sleep 1
    ds_read_b32 v124, v121
    s_waitcnt lgkmcnt(0)
    s_branch MK_PCK
MK_RC1:
    v_mov_b32 v110, v56
    v_mov_b32 v111, v56
    s_nop 1
    v_permlane32_swap_b32 v110, v111
    v_frexp_exp_i32_f32 v110, v111
    v_add_u32 v110, 80, v110
    v_max_i32 v110, 0, v110
    v_cvt_f32_i32 v110, v110
    v_mov_b32 v112, v104
    v_add_f32 v104, v104, v110
    v_sub_f32 v106, 0, v104
    v_and_b32 v107, 0xffff0000, v106
    v_sub_f32 v106, v106, v107
    v_cvt_pk_bf16_f32 v108, v107, v106
    v_and_b32 v106, 0xffff0000, v108
    v_add_f32 v106, v106, v107
    v_sub_f32 v104, 0, v106
    v_cndmask_b32 v76, v76, v108, s[56:57]
    v_sub_f32 v112, v112, v104
    v_cvt_i32_f32 v105, v112
    s_mov_b32 s46, 1
    s_branch MK_RCB1
MK_RS2:
    v_ldexp_f32 v48, v48, v105
    v_ldexp_f32 v49, v49, v105
    v_ldexp_f32 v50, v50, v105
    v_ldexp_f32 v51, v51, v105
    v_ldexp_f32 v52, v52, v105
    v_ldexp_f32 v53, v53, v105
    v_ldexp_f32 v54, v54, v105
    v_ldexp_f32 v55, v55, v105
    v_ldexp_f32 v56, v56, v105
    v_ldexp_f32 v57, v57, v105
    v_ldexp_f32 v58, v58, v105
    v_ldexp_f32 v59, v59, v105
    s_mov_b32 s46, 0
    s_branch MK_RSB2
MK_SLOW:
    v_cndmask_b32 v76, v76, 0, s[56:57]
    v_lshlrev_b32 v96, 4, v2
    v_lshlrev_b32 v97, 3, v3
    v_min_u32 v5, 19, v3
    v_mad_u32_u24 v5, v4, 20, v5
    v_lshlrev_b32 v99, 4, v5
    v_mov_b32 v5, 0x3f803f80
    v_cndmask_b32 v101, 0, v5, s[60:61]
    v_mov_b32 v104, 0xff800000
    s_mul_i32 s50, s38, 163840
    s_add_u32 s50, s50, 0x280000
    s_mov_b32 s45, 64
    v_mov_b32 v48, 0
    v_mov_b32 v49, 0
    v_mov_b32 v50, 0
    v_mov_b32 v51, 0
    v_mov_b32 v52, 0
    v_mov_b32 v53, 0
    v_mov_b32 v54, 0
    v_mov_b32 v55, 0
    v_mov_b32 v56, 0
    v_mov_b32 v57, 0
    v_mov_b32 v58, 0
    v_mov_b32 v59, 0
    v_mov_b32 v60, 0
    v_mov_b32 v61, 0
    v_mov_b32 v62, 0
    v_mov_b32 v63, 0
MK_SL:
    buffer_load_dwordx4 v[80:83], v96, s[16:19], s50 offen sc1
    buffer_load_dwordx2 v[84:85], v97, s[16:19], s50 offen offset:1024 sc1
    buffer_load_dwordx4 v[88:91], v99, s[16:19], s50 offen offset:1280 sc1
    buffer_load_dwordx4 v[92:95], v99, s[16:19], s50 offen offset:1920 sc1
    s_waitcnt vmcnt(0)
    v_mfma_f32_32x32x16_bf16 v[16:31], v[80:83], v[72:75], 0
    v_mfma_f32_32x32x8_bf16 v[16:31], v[84:85], v[76:77], v[16:31]
    v_cndmask_b32 v88, v101, v88, s[58:59]
    v_cndmask_b32 v89, v101, v89, s[58:59]
    v_cndmask_b32 v90, v101, v90, s[58:59]
    v_cndmask_b32 v91, v101, v91, s[58:59]
    v_cndmask_b32 v92, v101, v92, s[58:59]
    v_cndmask_b32 v93, v101, v93, s[58:59]
    v_cndmask_b32 v94, v101, v94, s[58:59]
    v_cndmask_b32 v95, v101, v95, s[58:59]
    s_nop 3
    v_max3_f32 v106, v16, v17, v18
    v_max_f32 v106, v106, v31
    v_max3_f32 v106, v106, v19, v20
    v_max3_f32 v106, v106, v21, v22
    v_max3_f32 v106, v106, v23, v24
    v_max3_f32 v106, v106, v25, v26
    v_max3_f32 v106, v106, v27, v28
    v_max3_f32 v106, v106, v29, v30
    v_mov_b32 v107, v106
    s_nop 1
    v_permlane32_swap_b32 v106, v107
    v_max3_f32 v106, v106, v107, v104
    v_sub_f32 v107, v104, v106
    v_exp_f32 v107, v107
    v_mov_b32 v104, v106
    v_sub_f32 v16, v16, v106
    v_sub_f32 v17, v17, v106
    v_sub_f32 v18, v18, v106
    v_sub_f32 v19, v19, v106
    v_sub_f32 v20, v20, v106
    v_sub_f32 v21, v21, v106
    v_sub_f32 v22, v22, v106
    v_sub_f32 v23, v23, v106
    v_sub_f32 v24, v24, v106
    v_sub_f32 v25, v25, v106
    v_sub_f32 v26, v26, v106
    v_sub_f32 v27, v27, v106
    v_sub_f32 v28, v28, v106
    v_sub_f32 v29, v29, v106
    v_sub_f32 v30, v30, v106
    v_sub_f32 v31, v31, v106
    v_exp_f32 v16, v16
    v_exp_f32 v17, v17
    v_exp_f32 v18, v18
    v_exp_f32 v19, v19
    v_exp_f32 v20, v20
    v_exp_f32 v21, v21
    v_exp_f32 v22, v22
    v_exp_f32 v23, v23
    v_exp_f32 v24, v24
    v_exp_f32 v25, v25
    v_exp_f32 v26, v26
    v_exp_f32 v27, v27
    v_exp_f32 v28, v28
    v_exp_f32 v29, v29
    v_exp_f32 v30, v30
    v_exp_f32 v31, v31
    v_mul_f32 v48, v48, v107
    v_mul_f32 v49, v49, v107
    v_mul_f32 v50, v50, v107
    v_mul_f32 v51, v51, v107
    v_mul_f32 v52, v52, v107
    v_mul_f32 v53, v53, v107
    v_mul_f32 v54, v54, v107
    v_mul_f32 v55, v55, v107
    v_mul_f32 v56, v56, v107
    v_mul_f32 v57, v57, v107
    v_mul_f32 v58, v58, v107
    v_mul_f32 v59, v59, v107
    v_cvt_pk_bf16_f32 v64, v16, v17
    v_cvt_pk_bf16_f32 v65, v18, v19
    v_cvt_pk_bf16_f32 v66, v20, v21
    v_cvt_pk_bf16_f32 v67, v22, v23
    v_cvt_pk_bf16_f32 v68, v24, v25
    v_cvt_pk_bf16_f32 v69, v26, v27
    v_cvt_pk_bf16_f32 v70, v28, v29
    v_cvt_pk_bf16_f32 v71, v30, v31
    v_mfma_f32_32x32x16_bf16 v[48:63], v[88:91], v[64:67], v[48:63]
    s_nop 0
    v_mfma_f32_32x32x16_bf16 v[48:63], v[92:95], v[68:71], v[48:63]
    s_add_u32 s50, s50, 2560
    s_sub_u32 s45, s45, 1
    s_cmp_lg_u32 s45, 0
    s_cbranch_scc1 MK_SL
    s_mov_b32 s45, 1
    s_branch MK_ATT_FIN
MK_AB3:
    s_mov_b32 s8, s64
    s_mov_b32 s9, s65
    s_mov_b32 s10, 0x280000
    s_mov_b32 s11, 0x00020000
    s_mov_b32 s12, s80
    s_mov_b32 s13, s81
    s_mov_b32 s14, 0x280000
    s_mov_b32 s15, 0x00020000
    s_mul_i32 s46, s38, 81920
    s_mul_i32 s47, s39, 160
    s_add_u32 s46, s46, s47
    v_mov_b32 v6, v103
    v_and_b32 v4, 7, v2
    v_lshlrev_b32 v4, 2, v4
    v_add_u32 v4, 162912, v4
    v_lshlrev_b32 v3, 4, v2
    s_lshr_b32 s40, s33, 2
    s_and_b32 s41, s33, 3
    s_mul_i32 s50, s40, 10752
    s_add_u32 s50, s50, 98304
    v_add_u32 v13, s50, v3
    s_lshl_b32 s42, s38, 2
    s_add_u32 s42, s42, s41
    s_mul_i32 s42, s42, 44
    s_lshl_b32 s50, s40, 1
    s_add_u32 s42, s42, s50
    s_lshl_b32 s42, s42, 10
    s_add_u32 s42, s42, 0x1080000
    s_waitcnt vmcnt(0)
    v_mov_b32 v5, 9
    ds_write_b32 v6, v5 offset:32
    s_mov_b64 exec, 1
    v_mov_b32 v14, 162832
    v_mov_b32 v15, 1
    ds_add_rtn_u32 v15, v14, v15
    s_waitcnt lgkmcnt(0)
    v_readfirstlane_b32 s50, v15
    s_nop 0
    s_cmp_lg_u32 s50, 7
    s_cbranch_scc1 MK_NOS6
    s_lshl_b32 s50, s39, 8
    s_add_u32 s50, s50, s38
    s_lshl_b32 s50, s50, 2
    s_add_u32 s50, s50, 0x1848000
    s_mov_b64 exec, 1
    v_mov_b32 v14, s86
    v_mov_b32 v15, 0
    buffer_store_dword v14, v15, s[16:19], s50 offen sc1
    s_mov_b64 exec, -1
MK_NOS6:
    s_mov_b64 exec, -1

MK_PW9:
    ds_read_b32 v5, v4
    s_waitcnt lgkmcnt(0)
    v_cmp_gt_u32 vcc, 9, v5
    s_cbranch_vccz MK_PD9
    s_sleep 1
    s_branch MK_PW9
MK_PD9:

    s_add_u32 m0, s43, s49
    s_cmp_ge_u32 s33, 4
    buffer_load_dwordx4 v3, s[16:19], s97 offen sc1 lds
    buffer_load_dwordx4 v3, s[16:19], s97 offen offset:1024 sc1 lds
    s_cbranch_scc1 MK_WR2
    buffer_load_dwordx4 v3, s[16:19], s97 offen offset:2048 sc1 lds
MK_WR2:
    s_add_u32 s97, s97, 20480
    s_add_u32 s49, s49, 21504
    s_cmp_eq_u32 s49, 64512
    s_cselect_b32 s49, 0, s49
    ds_read_b128 v[16:19], v13 offset:21504
    ds_read_b128 v[20:23], v13 offset:22528
    ds_read_b128 v[24:27], v13 offset:23552
    ds_read_b128 v[28:31], v13 offset:24576
    ds_read_b128 v[32:35], v13 offset:25600
    s_waitcnt lgkmcnt(5)
    ds_read_b128 v[36:39], v13 offset:26880
    ds_read_b128 v[40:43], v13 offset:27904
    ds_read_b128 v[44:47], v13 offset:28928
    ds_read_b128 v[48:51], v13 offset:29952
    ds_read_b128 v[52:55], v13 offset:30976
    s_waitcnt lgkmcnt(5)
    ds_read_b128 v[56:59], v13 offset:43008
    ds_read_b128 v[60:63], v13 offset:44032
    ds_read_b128 v[64:67], v13 offset:45056
    ds_read_b128 v[68:71], v13 offset:46080
    ds_read_b128 v[72:75], v13 offset:47104
    s_waitcnt lgkmcnt(5)
    ds_read_b128 v[76:79], v13 offset:48384
    ds_read_b128 v[80:83], v13 offset:49408
    ds_read_b128 v[84:87], v13 offset:50432
    ds_read_b128 v[88:91], v13 offset:51456
    ds_read_b128 v[92:95], v13 offset:52480
    s_waitcnt lgkmcnt(5)
    v_add_u32 v14, 0, v0
    v_mul_u32_u24 v15, 3277, v14
    v_lshrrev_b32 v15, 16, v15
    v_mul_u32_u24 v136, 20, v15
    v_sub_u32 v14, v14, v136
    v_mul_u32_u24 v136, 1280, v15
    v_lshl_add_u32 v136, v14, 3, v136
    v_add_u32 v14, 512, v0
    v_mul_u32_u24 v15, 3277, v14
    v_lshrrev_b32 v15, 16, v15
    v_mul_u32_u24 v137, 20, v15
    v_sub_u32 v14, v14, v137
    v_mul_u32_u24 v137, 1280, v15
    v_lshl_add_u32 v137, v14, 3, v137
    v_add_u32 v14, 1024, v0
    v_mul_u32_u24 v15, 3277, v14
    v_lshrrev_b32 v15, 16, v15
    v_mul_u32_u24 v138, 20, v15
    v_sub_u32 v14, v14, v138
    v_mul_u32_u24 v138, 1280, v15
    v_lshl_add_u32 v138, v14, 3, v138
    s_waitcnt lgkmcnt(0)
    v_mov_b32 v5, 10
    ds_write_b32 v6, v5 offset:32
MK_PW10:
    ds_read_b32 v5, v4
    s_waitcnt lgkmcnt(0)
    v_cmp_gt_u32 vcc, 10, v5
    s_cbranch_vccz MK_PD10
    s_sleep 1
    s_branch MK_PW10
MK_PD10:

    s_add_u32 m0, s43, s49
    s_cmp_ge_u32 s33, 4
    buffer_load_dwordx4 v3, s[16:19], s97 offen sc1 lds
    buffer_load_dwordx4 v3, s[16:19], s97 offen offset:1024 sc1 lds
    s_cbranch_scc1 MK_WR3
    buffer_load_dwordx4 v3, s[16:19], s97 offen offset:2048 sc1 lds
MK_WR3:
    s_add_u32 s97, s97, 20480
    s_add_u32 s49, s49, 21504
    s_cmp_eq_u32 s49, 64512
    s_cselect_b32 s49, 0, s49
    s_add_u32 m0, s43, s49
    s_cmp_ge_u32 s33, 4
    buffer_load_dwordx4 v3, s[16:19], s97 offen sc1 lds
    buffer_load_dwordx4 v3, s[16:19], s97 offen offset:1024 sc1 lds
    s_cbranch_scc1 MK_WR4
    buffer_load_dwordx4 v3, s[16:19], s97 offen offset:2048 sc1 lds
MK_WR4:
    s_add_u32 s97, s97, 20480
    s_add_u32 s49, s49, 21504
    s_cmp_eq_u32 s49, 64512
    s_cselect_b32 s49, 0, s49
    buffer_load_dwordx2 v[160:161], v136, s[8:11], s46 offen
    buffer_load_dwordx2 v[162:163], v137, s[8:11], s46 offen
    buffer_load_dwordx2 v[164:165], v138, s[8:11], s46 offen
    s_cmp_lg_u32 s33, 0
    s_cbranch_scc1 MK_S6_NP
    s_lshl_b32 s55, s34, 10
    s_add_u32 s55, s55, 0x1848000
    v_and_b32 v14, 31, v2
    v_lshlrev_b32 v14, 2, v14
    s_mov_b32 s56, 0
MK_S6P:
    buffer_load_dword v15, v14, s[16:19], s55 offen sc1
    s_waitcnt vmcnt(0)
    v_cmp_ne_u32 vcc, s86, v15
    s_cbranch_vccz MK_S6P_OK
    s_add_u32 s56, s56, 1
    s_cmp_gt_u32 s56, 200000
    s_cbranch_scc1 MK_S6P_OK
    s_sleep 2
    s_branch MK_S6P
MK_S6P_OK:
    v_mov_b32 v14, 162988
    ds_write_b32 v14, v14
MK_S6_NP:
    v_mov_b32 v15, 162988
MK_E4:
    ds_read_b32 v14, v15
    s_waitcnt lgkmcnt(0)
    v_cmp_gt_u32 vcc, 1, v14
    s_cbranch_vccz MK_E4_OK
    s_sleep 1
    s_branch MK_E4
MK_E4_OK:
    s_add_u32 s50, s42, 0
    buffer_load_dwordx4 v[96:99], v3, s[16:19], s50 offen offset:0 sc1
    buffer_load_dwordx4 v[100:103], v3, s[16:19], s50 offen offset:1024 sc1
    s_add_u32 s50, s42, 4096
    buffer_load_dwordx4 v[104:107], v3, s[16:19], s50 offen offset:0 sc1
    buffer_load_dwordx4 v[108:111], v3, s[16:19], s50 offen offset:1024 sc1
    s_add_u32 s50, s42, 8192
    buffer_load_dwordx4 v[112:115], v3, s[16:19], s50 offen offset:0 sc1
    buffer_load_dwordx4 v[116:119], v3, s[16:19], s50 offen offset:1024 sc1
    s_add_u32 s50, s42, 12288
    buffer_load_dwordx4 v[120:123], v3, s[16:19], s50 offen offset:0 sc1
    buffer_load_dwordx4 v[124:127], v3, s[16:19], s50 offen offset:1024 sc1
    s_add_u32 s50, s42, 16384
    buffer_load_dwordx4 v[128:131], v3, s[16:19], s50 offen offset:0 sc1
    buffer_load_dwordx4 v[132:135], v3, s[16:19], s50 offen offset:1024 sc1

    s_waitcnt vmcnt(10)
    v_mov_b32 v5, 11
    ds_write_b32 v6, v5 offset:32
    s_waitcnt vmcnt(9)
    v_mfma_f32_16x16x32_bf16 v[140:143], v[16:19], v[96:99], 0
    v_mfma_f32_16x16x32_bf16 v[144:147], v[20:23], v[96:99], 0
    v_mfma_f32_16x16x32_bf16 v[148:151], v[24:27], v[96:99], 0
    v_mfma_f32_16x16x32_bf16 v[152:155], v[28:31], v[96:99], 0
    v_mfma_f32_16x16x32_bf16 v[156:159], v[32:35], v[96:99], 0
    s_waitcnt vmcnt(8)
    v_mfma_f32_16x16x32_bf16 v[140:143], v[36:39], v[100:103], v[140:143]
    v_mfma_f32_16x16x32_bf16 v[144:147], v[40:43], v[100:103], v[144:147]
    v_mfma_f32_16x16x32_bf16 v[148:151], v[44:47], v[100:103], v[148:151]
    v_mfma_f32_16x16x32_bf16 v[152:155], v[48:51], v[100:103], v[152:155]
    v_mfma_f32_16x16x32_bf16 v[156:159], v[52:55], v[100:103], v[156:159]
    s_waitcnt vmcnt(7)
    v_mfma_f32_16x16x32_bf16 v[140:143], v[56:59], v[104:107], v[140:143]
    v_mfma_f32_16x16x32_bf16 v[144:147], v[60:63], v[104:107], v[144:147]
    v_mfma_f32_16x16x32_bf16 v[148:151], v[64:67], v[104:107], v[148:151]
    v_mfma_f32_16x16x32_bf16 v[152:155], v[68:71], v[104:107], v[152:155]
    v_mfma_f32_16x16x32_bf16 v[156:159], v[72:75], v[104:107], v[156:159]
MK_PW11:
    ds_read_b32 v5, v4
    s_waitcnt lgkmcnt(0)
    v_cmp_gt_u32 vcc, 11, v5
    s_cbranch_vccz MK_PD11
    s_sleep 1
    s_branch MK_PW11
MK_PD11:
    ds_read_b128 v[16:19], v13 offset:0
    ds_read_b128 v[20:23], v13 offset:1024
    ds_read_b128 v[24:27], v13 offset:2048
    ds_read_b128 v[28:31], v13 offset:3072
    ds_read_b128 v[32:35], v13 offset:4096
    s_waitcnt vmcnt(6)
    v_mfma_f32_16x16x32_bf16 v[140:143], v[76:79], v[108:111], v[140:143]
    v_mfma_f32_16x16x32_bf16 v[144:147], v[80:83], v[108:111], v[144:147]
    v_mfma_f32_16x16x32_bf16 v[148:151], v[84:87], v[108:111], v[148:151]
    v_mfma_f32_16x16x32_bf16 v[152:155], v[88:91], v[108:111], v[152:155]
    v_mfma_f32_16x16x32_bf16 v[156:159], v[92:95], v[108:111], v[156:159]
    ds_read_b128 v[36:39], v13 offset:5376
    ds_read_b128 v[40:43], v13 offset:6400
    ds_read_b128 v[44:47], v13 offset:7424
    ds_read_b128 v[48:51], v13 offset:8448
    ds_read_b128 v[52:55], v13 offset:9472
    s_waitcnt lgkmcnt(5)
    s_waitcnt vmcnt(5)
    v_mfma_f32_16x16x32_bf16 v[140:143], v[16:19], v[112:115], v[140:143]
    v_mfma_f32_16x16x32_bf16 v[144:147], v[20:23], v[112:115], v[144:147]
    v_mfma_f32_16x16x32_bf16 v[148:151], v[24:27], v[112:115], v[148:151]
    v_mfma_f32_16x16x32_bf16 v[152:155], v[28:31], v[112:115], v[152:155]
    v_mfma_f32_16x16x32_bf16 v[156:159], v[32:35], v[112:115], v[156:159]
    ds_read_b128 v[56:59], v13 offset:21504
    ds_read_b128 v[60:63], v13 offset:22528
    ds_read_b128 v[64:67], v13 offset:23552
    ds_read_b128 v[68:71], v13 offset:24576
    ds_read_b128 v[72:75], v13 offset:25600
    s_waitcnt lgkmcnt(5)
    s_waitcnt vmcnt(4)
    v_mfma_f32_16x16x32_bf16 v[140:143], v[36:39], v[116:119], v[140:143]
    v_mfma_f32_16x16x32_bf16 v[144:147], v[40:43], v[116:119], v[144:147]
    v_mfma_f32_16x16x32_bf16 v[148:151], v[44:47], v[116:119], v[148:151]
    v_mfma_f32_16x16x32_bf16 v[152:155], v[48:51], v[116:119], v[152:155]
    v_mfma_f32_16x16x32_bf16 v[156:159], v[52:55], v[116:119], v[156:159]
    ds_read_b128 v[76:79], v13 offset:26880
    ds_read_b128 v[80:83], v13 offset:27904
    ds_read_b128 v[84:87], v13 offset:28928
    ds_read_b128 v[88:91], v13 offset:29952
    ds_read_b128 v[92:95], v13 offset:30976
    s_waitcnt lgkmcnt(5)
    s_waitcnt vmcnt(3)
    v_mfma_f32_16x16x32_bf16 v[140:143], v[56:59], v[120:123], v[140:143]
    v_mfma_f32_16x16x32_bf16 v[144:147], v[60:63], v[120:123], v[144:147]
    v_mfma_f32_16x16x32_bf16 v[148:151], v[64:67], v[120:123], v[148:151]
    v_mfma_f32_16x16x32_bf16 v[152:155], v[68:71], v[120:123], v[152:155]
    v_mfma_f32_16x16x32_bf16 v[156:159], v[72:75], v[120:123], v[156:159]
    ds_read_b128 v[16:19], v13 offset:43008
    ds_read_b128 v[20:23], v13 offset:44032
    ds_read_b128 v[24:27], v13 offset:45056
    ds_read_b128 v[28:31], v13 offset:46080
    ds_read_b128 v[32:35], v13 offset:47104
    s_waitcnt lgkmcnt(5)
    s_waitcnt vmcnt(2)
    v_mfma_f32_16x16x32_bf16 v[140:143], v[76:79], v[124:127], v[140:143]
    v_mfma_f32_16x16x32_bf16 v[144:147], v[80:83], v[124:127], v[144:147]
    v_mfma_f32_16x16x32_bf16 v[148:151], v[84:87], v[124:127], v[148:151]
    v_mfma_f32_16x16x32_bf16 v[152:155], v[88:91], v[124:127], v[152:155]
    v_mfma_f32_16x16x32_bf16 v[156:159], v[92:95], v[124:127], v[156:159]
    ds_read_b128 v[36:39], v13 offset:48384
    ds_read_b128 v[40:43], v13 offset:49408
    ds_read_b128 v[44:47], v13 offset:50432
    ds_read_b128 v[48:51], v13 offset:51456
    ds_read_b128 v[52:55], v13 offset:52480
    s_waitcnt lgkmcnt(5)
    s_waitcnt vmcnt(1)
    v_mfma_f32_16x16x32_bf16 v[140:143], v[16:19], v[128:131], v[140:143]
    v_mfma_f32_16x16x32_bf16 v[144:147], v[20:23], v[128:131], v[144:147]
    v_mfma_f32_16x16x32_bf16 v[148:151], v[24:27], v[128:131], v[148:151]
    v_mfma_f32_16x16x32_bf16 v[152:155], v[28:31], v[128:131], v[152:155]
    v_mfma_f32_16x16x32_bf16 v[156:159], v[32:35], v[128:131], v[156:159]
    s_waitcnt lgkmcnt(0)
    s_waitcnt vmcnt(0)
    v_mfma_f32_16x16x32_bf16 v[140:143], v[36:39], v[132:135], v[140:143]
    v_mfma_f32_16x16x32_bf16 v[144:147], v[40:43], v[132:135], v[144:147]
    v_mfma_f32_16x16x32_bf16 v[148:151], v[44:47], v[132:135], v[148:151]
    v_mfma_f32_16x16x32_bf16 v[152:155], v[48:51], v[132:135], v[152:155]
    v_mfma_f32_16x16x32_bf16 v[156:159], v[52:55], v[132:135], v[156:159]
    v_mov_b32 v5, 12
    ds_write_b32 v6, v5 offset:32
    v_and_b32 v7, 15, v2
    v_mul_u32_u24 v7, 336, v7
    v_lshrrev_b32 v8, 4, v2
    v_lshl_add_u32 v7, v8, 4, v7
    s_mul_i32 s50, s40, 21504
    s_mul_i32 s51, s41, 5376
    s_add_u32 s50, s50, s51
    s_add_u32 s50, s50, 98304
    v_add_u32 v7, s50, v7
    v_add_u32 v14, 0, v0
    v_mul_u32_u24 v15, 3277, v14
    v_lshrrev_b32 v15, 16, v15
    v_mul_u32_u24 v100, 20, v15
    v_sub_u32 v14, v14, v100
    v_mul_u32_u24 v100, 336, v15
    v_lshl_add_u32 v100, v14, 4, v100
    v_add_u32 v104, 49152, v100
    v_add_u32 v108, 98304, v100
    v_lshlrev_b32 v120, 16, v160
    v_and_b32 v121, 0xffff0000, v160
    v_lshlrev_b32 v122, 16, v161
    v_and_b32 v123, 0xffff0000, v161
    v_add_u32 v14, 512, v0
    v_mul_u32_u24 v15, 3277, v14
    v_lshrrev_b32 v15, 16, v15
    v_mul_u32_u24 v101, 20, v15
    v_sub_u32 v14, v14, v101
    v_mul_u32_u24 v101, 336, v15
    v_lshl_add_u32 v101, v14, 4, v101
    v_add_u32 v105, 49152, v101
    v_add_u32 v109, 98304, v101
    v_lshlrev_b32 v124, 16, v162
    v_and_b32 v125, 0xffff0000, v162
    v_lshlrev_b32 v126, 16, v163
    v_and_b32 v127, 0xffff0000, v163
    v_add_u32 v14, 1024, v0
    v_mul_u32_u24 v15, 3277, v14
    v_lshrrev_b32 v15, 16, v15
    v_mul_u32_u24 v102, 20, v15
    v_sub_u32 v14, v14, v102
    v_mul_u32_u24 v102, 336, v15
    v_lshl_add_u32 v102, v14, 4, v102
    v_add_u32 v106, 49152, v102
    v_add_u32 v110, 98304, v102
    v_lshlrev_b32 v128, 16, v164
    v_and_b32 v129, 0xffff0000, v164
    v_lshlrev_b32 v130, 16, v165
    v_and_b32 v131, 0xffff0000, v165
MK_PW12:
    ds_read_b32 v5, v4
    s_waitcnt lgkmcnt(0)
    v_cmp_gt_u32 vcc, 12, v5
    s_cbranch_vccz MK_PD12
    s_sleep 1
    s_branch MK_PW12
MK_PD12:
    ds_write_b128 v7, v[140:143] offset:0
    ds_write_b128 v7, v[144:147] offset:64
    ds_write_b128 v7, v[148:151] offset:128
    ds_write_b128 v7, v[152:155] offset:192
    ds_write_b128 v7, v[156:159] offset:256

    s_waitcnt lgkmcnt(0)
    s_barrier
    s_cmp_ge_u32 s33, 4
    s_cbranch_scc1 MK_F2
    ds_read_b128 v[16:19], v100 offset:0
    ds_read_b128 v[20:23], v100 offset:24576
    ds_read_b128 v[24:27], v104 offset:0
    ds_read_b128 v[28:31], v104 offset:24576
    ds_read_b128 v[32:35], v108 offset:0
    ds_read_b128 v[36:39], v108 offset:21504
    ds_read_b128 v[40:43], v101 offset:0
    ds_read_b128 v[44:47], v101 offset:24576
    ds_read_b128 v[48:51], v105 offset:0
    ds_read_b128 v[52:55], v105 offset:24576
    ds_read_b128 v[56:59], v109 offset:0
    ds_read_b128 v[60:63], v109 offset:21504
    s_waitcnt lgkmcnt(6)
    ds_read_b128 v[64:67], v102 offset:0
    ds_read_b128 v[68:71], v102 offset:24576
    ds_read_b128 v[72:75], v106 offset:0
    ds_read_b128 v[76:79], v106 offset:24576
    ds_read_b128 v[80:83], v110 offset:0
    ds_read_b128 v[84:87], v110 offset:21504
    s_waitcnt lgkmcnt(12)
    v_add_f32 v16, v16, v20
    v_add_f32 v24, v24, v28
    v_add_f32 v32, v32, v36
    v_add_f32 v17, v17, v21
    v_add_f32 v25, v25, v29
    v_add_f32 v33, v33, v37
    v_add_f32 v18, v18, v22
    v_add_f32 v26, v26, v30
    v_add_f32 v34, v34, v38
    v_add_f32 v19, v19, v23
    v_add_f32 v27, v27, v31
    v_add_f32 v35, v35, v39
    v_add_f32 v16, v16, v120
    v_add_f32 v17, v17, v121
    v_add_f32 v18, v18, v122
    v_add_f32 v19, v19, v123
    v_add_f32 v24, v24, v32
    v_add_f32 v25, v25, v33
    v_add_f32 v26, v26, v34
    v_add_f32 v27, v27, v35
    v_add_f32 v16, v16, v24
    v_add_f32 v17, v17, v25
    v_add_f32 v18, v18, v26
    v_add_f32 v19, v19, v27
    v_cvt_pk_bf16_f32 v16, v16, v17
    v_cvt_pk_bf16_f32 v17, v18, v19
    buffer_store_dwordx2 v[16:17], v136, s[12:15], s46 offen
    s_waitcnt lgkmcnt(6)
    v_add_f32 v40, v40, v44
    v_add_f32 v48, v48, v52
    v_add_f32 v56, v56, v60
    v_add_f32 v41, v41, v45
    v_add_f32 v49, v49, v53
    v_add_f32 v57, v57, v61
    v_add_f32 v42, v42, v46
    v_add_f32 v50, v50, v54
    v_add_f32 v58, v58, v62
    v_add_f32 v43, v43, v47
    v_add_f32 v51, v51, v55
    v_add_f32 v59, v59, v63
    v_add_f32 v40, v40, v124
    v_add_f32 v41, v41, v125
    v_add_f32 v42, v42, v126
    v_add_f32 v43, v43, v127
    v_add_f32 v48, v48, v56
    v_add_f32 v49, v49, v57
    v_add_f32 v50, v50, v58
    v_add_f32 v51, v51, v59
    v_add_f32 v40, v40, v48
    v_add_f32 v41, v41, v49
    v_add_f32 v42, v42, v50
    v_add_f32 v43, v43, v51
    v_cvt_pk_bf16_f32 v40, v40, v41
    v_cvt_pk_bf16_f32 v41, v42, v43
    buffer_store_dwordx2 v[40:41], v137, s[12:15], s46 offen
    s_waitcnt lgkmcnt(0)
    v_add_f32 v64, v64, v68
    v_add_f32 v72, v72, v76
    v_add_f32 v80, v80, v84
    v_add_f32 v65, v65, v69
    v_add_f32 v73, v73, v77
    v_add_f32 v81, v81, v85
    v_add_f32 v66, v66, v70
    v_add_f32 v74, v74, v78
    v_add_f32 v82, v82, v86
    v_add_f32 v67, v67, v71
    v_add_f32 v75, v75, v79
    v_add_f32 v83, v83, v87
    v_add_f32 v64, v64, v128
    v_add_f32 v65, v65, v129
    v_add_f32 v66, v66, v130
    v_add_f32 v67, v67, v131
    v_add_f32 v72, v72, v80
    v_add_f32 v73, v73, v81
    v_add_f32 v74, v74, v82
    v_add_f32 v75, v75, v83
    v_add_f32 v64, v64, v72
    v_add_f32 v65, v65, v73
    v_add_f32 v66, v66, v74
    v_add_f32 v67, v67, v75
    v_cvt_pk_bf16_f32 v64, v64, v65
    v_cvt_pk_bf16_f32 v65, v66, v67
    buffer_store_dwordx2 v[64:65], v138, s[12:15], s46 offen
    s_branch MK_F3
MK_F2:
    ds_read_b128 v[16:19], v100 offset:0
    ds_read_b128 v[20:23], v100 offset:24576
    ds_read_b128 v[24:27], v104 offset:0
    ds_read_b128 v[28:31], v104 offset:24576
    ds_read_b128 v[32:35], v108 offset:0
    ds_read_b128 v[36:39], v108 offset:21504
    ds_read_b128 v[40:43], v101 offset:0
    ds_read_b128 v[44:47], v101 offset:24576
    ds_read_b128 v[48:51], v105 offset:0
    ds_read_b128 v[52:55], v105 offset:24576
    ds_read_b128 v[56:59], v109 offset:0
    ds_read_b128 v[60:63], v109 offset:21504
    s_waitcnt lgkmcnt(6)
    v_add_f32 v16, v16, v20
    v_add_f32 v24, v24, v28
    v_add_f32 v32, v32, v36
    v_add_f32 v17, v17, v21
    v_add_f32 v25, v25, v29
    v_add_f32 v33, v33, v37
    v_add_f32 v18, v18, v22
    v_add_f32 v26, v26, v30
    v_add_f32 v34, v34, v38
    v_add_f32 v19, v19, v23
    v_add_f32 v27, v27, v31
    v_add_f32 v35, v35, v39
    v_add_f32 v16, v16, v120
    v_add_f32 v17, v17, v121
    v_add_f32 v18, v18, v122
    v_add_f32 v19, v19, v123
    v_add_f32 v24, v24, v32
    v_add_f32 v25, v25, v33
    v_add_f32 v26, v26, v34
    v_add_f32 v27, v27, v35
    v_add_f32 v16, v16, v24
    v_add_f32 v17, v17, v25
    v_add_f32 v18, v18, v26
    v_add_f32 v19, v19, v27
    v_cvt_pk_bf16_f32 v16, v16, v17
    v_cvt_pk_bf16_f32 v17, v18, v19
    buffer_store_dwordx2 v[16:17], v136, s[12:15], s46 offen
    s_waitcnt lgkmcnt(0)
    v_add_f32 v40, v40, v44
    v_add_f32 v48, v48, v52
    v_add_f32 v56, v56, v60
    v_add_f32 v41, v41, v45
    v_add_f32 v49, v49, v53
    v_add_f32 v57, v57, v61
    v_add_f32 v42, v42, v46
    v_add_f32 v50, v50, v54
    v_add_f32 v58, v58, v62
    v_add_f32 v43, v43, v47
    v_add_f32 v51, v51, v55
    v_add_f32 v59, v59, v63
    v_add_f32 v40, v40, v124
    v_add_f32 v41, v41, v125
    v_add_f32 v42, v42, v126
    v_add_f32 v43, v43, v127
    v_add_f32 v48, v48, v56
    v_add_f32 v49, v49, v57
    v_add_f32 v50, v50, v58
    v_add_f32 v51, v51, v59
    v_add_f32 v40, v40, v48
    v_add_f32 v41, v41, v49
    v_add_f32 v42, v42, v50
    v_add_f32 v43, v43, v51
    v_cvt_pk_bf16_f32 v40, v40, v41
    v_cvt_pk_bf16_f32 v41, v42, v43
    buffer_store_dwordx2 v[40:41], v137, s[12:15], s46 offen
MK_F3:

MK_END:
    s_endpgm
CODE_END:
    s_endpgm
.section .rodata,"a"
.p2align 6
.amdhsa_kernel parallel_sum__softmax_full_mha__mixer_gmlp__prompt_kernel
  .amdhsa_next_free_vgpr 168
  .amdhsa_next_free_sgpr 102
  .amdhsa_accum_offset 168
  .amdhsa_group_segment_fixed_size 0
  .amdhsa_kernarg_size 88
  .amdhsa_user_sgpr_count 2
  .amdhsa_user_sgpr_kernarg_segment_ptr 1
  .amdhsa_system_sgpr_workgroup_id_x 1
.end_amdhsa_kernel
```
